```python
import torch

def _softmax(x, axis=-1):
    return torch.softmax(x, dim=axis)

def _gelu(x):
    return torch.nn.functional.gelu(x, approximate='tanh')

def _silu(x):
    return torch.nn.functional.silu(x)

def _sigmoid(x):
    return torch.sigmoid(x)

def _layernorm(x, axis=-1, eps=1e-05):
    m = x.mean(dim=axis, keepdim=True)
    v = x.var(dim=axis, keepdim=True, unbiased=False)
    return (x - m) / torch.sqrt(v + eps)

def _scatter_add(tgt, idx, src, axis=0):
    return tgt.clone().index_add_(axis, idx, src)

def _segment_sum(src, seg, n):
    out = torch.zeros((n,) + src.shape[1:], dtype=src.dtype)
    return out.index_add_(0, seg, src)

def _pad(x, pw):
    flat = tuple((v for pair in reversed(pw) for v in pair))
    return torch.nn.functional.pad(x, flat)
kernel_name = 'adaLN_cond__linear_kernel_hedgehog__geglu_ffn__prompt'

def setup_inputs():

    _w = lambda a: (lambda t: t.to(torch.bfloat16) if t.is_floating_point() else t)(torch.as_tensor(a))

    def _A_setup():
        B, S, D, H = (1, 2048, 448, 16)
        Dh = D // H
        return {'x': _w((lambda *s: torch.randn(*s, dtype=torch.bfloat16) * 0.05)(B, S, D)), 'wqkv': _w((lambda *s: torch.randn(*s, dtype=torch.bfloat16) * 0.4)(D, 3 * D)), 'w_phi': _w((lambda *s: torch.randn(*s, dtype=torch.bfloat16) * 0.4)(H, Dh, Dh) * Dh ** (-0.5)), 'wo': _w((lambda *s: torch.randn(*s, dtype=torch.bfloat16) * 0.05)(D, D))}
    _A_in = _A_setup()

    def _B_setup():
        B, S, D, F = (1, 2048, 448, 1792)
        return {'x': _w((lambda *s: torch.randn(*s, dtype=torch.bfloat16) * 0.05)(B, S, D)), 'w_gate': _w((lambda *s: torch.randn(*s, dtype=torch.bfloat16) * 0.05)(D, F)), 'w_up': _w((lambda *s: torch.randn(*s, dtype=torch.bfloat16) * 0.05)(D, F)), 'w_down': _w((lambda *s: torch.randn(*s, dtype=torch.bfloat16) * 0.05)(F, D))}
    _B_in = _B_setup()
    return {'A_x': _A_in['x'], 'A_wqkv': _A_in['wqkv'], 'A_w_phi': _A_in['w_phi'], 'A_wo': _A_in['wo'], 'B_x': _B_in['x'], 'B_w_gate': _B_in['w_gate'], 'B_w_up': _B_in['w_up'], 'B_w_down': _B_in['w_down'], 'c': _w((lambda *s: torch.randn(*s, dtype=torch.bfloat16) * 0.1)(1, 448) * 8.0), 'w_mod': _w((lambda *s: torch.randn(*s, dtype=torch.bfloat16) * 0.1)(448, 6 * 448) * 448 ** (-0.5) * 8.0)}

def reference(A_x, A_wqkv, A_w_phi, A_wo, B_x, B_w_gate, B_w_up, B_w_down, c, w_mod):

    def _A_ref(x, wqkv, w_phi, wo):
        B, S, D = x.shape
        H = 16
        Dh = D // H
        qkv = (lambda x, *d: x.permute(*d))((x @ wqkv).reshape(B, S, 3, H, Dh), 2, 0, 3, 1, 4)
        q, k, v = (qkv[0], qkv[1], qkv[2])
        pq = torch.einsum('bhsd,hdf->bhsf', q, w_phi)
        pk = torch.einsum('bhsd,hdf->bhsf', k, w_phi)
        phi_q = torch.concatenate([_softmax(pq, axis=-1), _softmax(-pq, axis=-1)], axis=-1)
        phi_k = torch.concatenate([_softmax(pk, axis=-1), _softmax(-pk, axis=-1)], axis=-1)
        kv = torch.einsum('bhsf,bhsd->bhfd', phi_k, v)
        z = torch.einsum('bhsf->bhf', phi_k)
        num = torch.einsum('bhqf,bhfd->bhqd', phi_q, kv)
        den = torch.einsum('bhqf,bhf->bhq', phi_q, z)[..., None] + 1e-06
        o = num / den
        return (lambda x, *d: x.permute(*d))(o, 0, 2, 1, 3).reshape(B, S, D) @ wo

    def _B_ref(x, w_gate, w_up, w_down):
        return _gelu(x @ w_gate) * (x @ w_up) @ w_down
    x = A_x
    mod = (_silu(c) @ w_mod).reshape(c.shape[0], 6, 1, -1)
    sa, ca, ga, sb, cb, gb = (mod[:, 0].clone(), mod[:, 1].clone(), mod[:, 2].clone(), mod[:, 3].clone(), mod[:, 4].clone(), mod[:, 5].clone())
    h = _layernorm(x, axis=-1) * (1 + ca) + sa
    x = x + ga * _A_ref(h, A_wqkv, A_w_phi, A_wo)
    h = _layernorm(x, axis=-1) * (1 + cb) + sb
    x = x + gb * _B_ref(h, B_w_gate, B_w_up, B_w_down)
    return x
```

```asm
; @launch grid=(256,1,1) block=(512,1,1) lds=163840
.amdgcn_target "amdgcn-amd-amdhsa--gfx950"
.text
.globl adaLN_cond__linear_kernel_hedgehog__geglu_ffn__prompt_kernel
.p2align 8
.type adaLN_cond__linear_kernel_hedgehog__geglu_ffn__prompt_kernel,@function
adaLN_cond__linear_kernel_hedgehog__geglu_ffn__prompt_kernel:
    s_load_dwordx16 s[16:31], s[0:1], 0
    s_load_dwordx8 s[32:39], s[0:1], 64
    s_load_dwordx2 s[40:41], s[0:1], 96
    s_cmp_lt_u32 s2, 256
    s_cbranch_scc1 go
    s_endpgm
go:
    s_getpc_b64 s[60:61]
pc0:
    s_mov_b32 s62, code_end-pc0
    s_mov_b32 s63, 0x20000
    s_lshr_b32 s100, s2, 3
    v_lshlrev_b32 v4, 12, v0
    s_lshl_b32 s12, s100, 7
    v_cmp_gt_u32 vcc, 16, v0
    s_nop 0
    s_and_saveexec_b64 s[14:15], vcc
    s_cbranch_execz nopf
    buffer_load_dword v199, v4, s[60:63], s12 offen
nopf:
    s_mov_b64 exec, -1
    v_lshrrev_b32 v4, 6, v0
    v_and_b32 v5, 63, v0
    v_readfirstlane_b32 s3, v4
    s_and_b32 s12, s2, 7
    s_and_b32 s7, s12, 1
    s_lshr_b32 s12, s12, 1
    s_lshl_b32 s12, s12, 2
    s_and_b32 s4, s100, 3
    s_add_u32 s4, s4, s12
    s_lshr_b32 s6, s100, 2
    s_lshl_b32 s5, s7, 3
    s_add_u32 s5, s5, s6
    s_and_b32 s8, s3, 3
    v_lshlrev_b32 v1, 4, v5
    v_lshrrev_b32 v6, 3, v5
    v_lshrrev_b32 v7, 4, v5
    v_and_b32 v8, 7, v5
    v_mul_u32_u24 v10, 5376, v6
    v_lshl_add_u32 v10, v8, 4, v10
    v_xor_b32 v8, v8, v7
    v_mul_u32_u24 v16, 896, v6
    v_lshl_add_u32 v16, v8, 4, v16
    v_add_u32 v17, 7168, v16
    s_and_b32 s12, s100, 4
    s_xor_b32 s12, s12, s3
    s_lshl3_add_u32 s101, s4, s12
    s_mul_i32 s101, s101, 14336
    s_lshl_b32 s83, s6, 7
    s_cmp_eq_u32 s6, 7
    s_cselect_b32 s83, 0, s83
    s_lshr_b32 s15, s83, 5
    s_lshl1_add_u32 s12, s4, s7
    s_cmp_eq_u32 s6, 7
    s_cselect_b32 s9, s12, 99
    v_lshrrev_b32 v6, 2, v5
    v_and_b32 v7, 3, v5
    v_mul_u32_u24 v12, 2688, v6
    v_lshl_add_u32 v12, v7, 4, v12
    s_mul_i32 s82, s5, 56
    s_and_b32 s13, s5, 1
    s_lshl_b32 s13, s13, 3
    s_sub_u32 s82, s82, s13
    s_and_b32 s12, s4, 3
    s_mul_i32 s12, s12, 7
    s_xor_b32 s13, s3, 4
    s_add_u32 s12, s12, s13
    s_sub_u32 s13, s12, 28
    s_min_u32 s12, s12, s13
    s_lshl_b32 s72, s12, 10
    s_add_u32 s13, s12, s15
    s_sub_u32 s14, s13, 28
    s_min_u32 s96, s13, s14
    s_mul_i32 s78, s96, 43008
    s_add_u32 s78, s78, s82
    s_add_u32 s12, s12, 8
    s_sub_u32 s13, s12, 28
    s_min_u32 s12, s12, s13
    s_lshl_b32 s73, s12, 10
    s_add_u32 s13, s12, s15
    s_sub_u32 s14, s13, 28
    s_min_u32 s97, s13, s14
    s_mul_i32 s79, s97, 43008
    s_add_u32 s79, s79, s82
    s_add_u32 s12, s12, 8
    s_sub_u32 s13, s12, 28
    s_min_u32 s12, s12, s13
    s_lshl_b32 s74, s12, 10
    s_add_u32 s13, s12, s15
    s_sub_u32 s14, s13, 28
    s_min_u32 s98, s13, s14
    s_mul_i32 s80, s98, 43008
    s_add_u32 s80, s80, s82
    s_add_u32 s12, s12, 8
    s_sub_u32 s13, s12, 28
    s_min_u32 s12, s12, s13
    s_lshl_b32 s75, s12, 10
    s_add_u32 s13, s12, s15
    s_sub_u32 s14, s13, 28
    s_min_u32 s99, s13, s14
    s_mul_i32 s81, s99, 43008
    s_add_u32 s81, s81, s82
    s_waitcnt lgkmcnt(0)
    s_mov_b32 s48, s16
    s_mov_b32 s49, s17
    s_mov_b32 s50, 0x1c0000
    s_mov_b32 s51, 0x20000
    s_cmp_lt_u32 s3, 4
    s_cselect_b32 s12, s9, 99
    s_cmp_lt_u32 s12, 28
    s_cbranch_scc1 modld
    s_mov_b32 s52, s18
    s_mov_b32 s53, s19
    s_mov_b32 s54, 0x126000
    s_mov_b32 s55, 0x20000
    s_mov_b32 s44, s40
    s_mov_b32 s45, s41
    s_mov_b32 s46, 0x1000000
    s_mov_b32 s47, 0x20000
    s_load_dword s10, s[40:41], 0
    s_mov_b32 s68, s20
    s_mov_b32 s69, s21
    s_mov_b32 s70, 0x6200
    s_mov_b32 s71, 0x20000
    s_cmp_lt_u32 s3, 4
    s_cbranch_scc0 adr
    s_add_u32 s13, s101, s83
    buffer_load_dwordx4 v[200:203], v16, s[48:51], s13 offen
    buffer_load_dwordx4 v[204:207], v17, s[48:51], s13 offen
    s_add_u32 s83, s83, 128
    s_cmp_eq_u32 s83, 896
    s_cselect_b32 s83, 0, s83
    s_add_u32 s13, s101, s83
    buffer_load_dwordx4 v[208:211], v16, s[48:51], s13 offen
    buffer_load_dwordx4 v[212:215], v17, s[48:51], s13 offen
    s_add_u32 s83, s83, 128
    s_cmp_eq_u32 s83, 896
    s_cselect_b32 s83, 0, s83
    s_add_u32 s13, s101, s83
    buffer_load_dwordx4 v[216:219], v16, s[48:51], s13 offen
    buffer_load_dwordx4 v[220:223], v17, s[48:51], s13 offen
    s_add_u32 s83, s83, 128
    s_cmp_eq_u32 s83, 896
    s_cselect_b32 s83, 0, s83
    s_add_u32 s13, s101, s83
    buffer_load_dwordx4 v[224:227], v16, s[48:51], s13 offen
    buffer_load_dwordx4 v[228:231], v17, s[48:51], s13 offen
    s_add_u32 s83, s83, 128
    s_cmp_eq_u32 s83, 896
    s_cselect_b32 s83, 0, s83
    s_add_u32 s13, s101, s83
    buffer_load_dwordx4 v[232:235], v16, s[48:51], s13 offen
    buffer_load_dwordx4 v[236:239], v17, s[48:51], s13 offen
    s_add_u32 s83, s83, 128
    s_cmp_eq_u32 s83, 896
    s_cselect_b32 s83, 0, s83
    s_add_u32 s13, s101, s83
    buffer_load_dwordx4 v[240:243], v16, s[48:51], s13 offen
    buffer_load_dwordx4 v[244:247], v17, s[48:51], s13 offen
    s_add_u32 s83, s83, 128
    s_cmp_eq_u32 s83, 896
    s_cselect_b32 s83, 0, s83
    s_add_u32 s13, s101, s83
    buffer_load_dwordx4 v[248:251], v16, s[48:51], s13 offen
    buffer_load_dwordx4 v[252:255], v17, s[48:51], s13 offen
    s_add_u32 m0, s72, 23680
    s_nop 0
    buffer_load_dwordx4 v12, s[52:55], s78 offen offset:896 lds
    s_sub_u32 s13, s4, 7
    s_min_u32 s12, s4, s13
    s_cmp_lt_u32 s4, 7
    s_cselect_b32 s14, 1792, 0
    s_cselect_b32 s15, 0, 1
    s_mul_i32 s13, s3, 7
    s_add_u32 s99, s12, s13
    s_mul_i32 s81, s99, 43008
    s_add_u32 s81, s81, s82
    s_add_u32 s81, s81, s14
    s_lshl_b32 s75, s3, 10
    s_add_u32 s75, s75, 28672
    s_mul_i32 s12, s5, 73728
    s_add_u32 s12, s12, 6291456
    s_mul_i32 s13, s15, 28
    s_add_u32 s13, s13, s99
    s_lshl_b32 s13, s13, 10
    s_add_u32 s42, s12, s13
    s_lshl_b32 s13, s15, 5
    s_add_u32 s13, s13, s99
    s_lshl_b32 s13, s13, 8
    s_add_u32 s12, s12, s13
    s_add_u32 s43, s12, 57344
    s_min_u32 s99, s99, 27
    s_cmp_ge_u32 s4, 14
    s_cmov_b32 s81, 0x7f000000
    s_cmov_b32 s42, 0x7f000000
    s_cmov_b32 s43, 0x7f000000
adr:
    s_cmp_lt_u32 s3, 4
    s_cselect_b32 s60, s26, s28
    s_cselect_b32 s61, s27, s29
    s_mov_b32 s62, 1605632
    s_mov_b32 s63, 0x20000
    s_mov_b32 s11, 0x10000
    s_lshl_b32 s12, s5, 3
    s_add_u32 s12, s12, s3
    s_lshl_b32 s13, s12, 13
    s_add_u32 s20, s13, 1048576
    s_mov_b32 s56, s22
    s_mov_b32 s57, s23
    s_mov_b32 s58, 0x62000
    s_mov_b32 s59, 0x20000
    s_and_b32 s12, s100, 4
    s_xor_b32 s12, s12, s3
    s_lshl3_add_u32 s12, s4, s12
    s_mul_i32 s12, s12, 56
    s_lshr_b32 s13, s5, 1
    s_mul_i32 s13, s13, 7
    s_add_u32 s12, s12, s13
    s_lshl_b32 s12, s12, 8
    s_add_u32 s12, s12, 2097152
    s_and_b32 s13, s5, 1
    s_mul_i32 s21, s13, 768
    s_add_u32 s21, s21, s12
    s_lshl_b32 s13, s13, 3
    s_add_u32 s22, s12, s13
    s_add_u32 s22, s22, 768
    v_mov_b32 v124, -1
    v_mov_b32 v125, -1
    v_mov_b32 v126, -1
    v_mov_b32 v127, -1
    v_bfe_u32 v2, v1, 4, 5
    v_lshrrev_b32 v3, 9, v1
    v_bfe_u32 v4, v1, 4, 4
    v_bfe_u32 v5, v1, 8, 1
    v_lshlrev_b32 v6, 2, v5
    v_cmp_eq_u32 vcc, v4, v6
    v_lshlrev_b32 v7, 4, v3
    s_nop 0
    v_cndmask_b32 v7, 32, v7, vcc
    v_lshlrev_b32 v8, 5, v3
    s_lshl_b32 s12, s96, 6
    v_add_u32 v64, s12, v8
    s_mul_i32 s12, s96, 48
    v_add_u32 v68, s12, v7
    s_lshl_b32 s12, s97, 6
    v_add_u32 v65, s12, v8
    s_mul_i32 s12, s97, 48
    v_add_u32 v69, s12, v7
    s_lshl_b32 s12, s98, 6
    v_add_u32 v66, s12, v8
    s_mul_i32 s12, s98, 48
    v_add_u32 v70, s12, v7
    s_lshl_b32 s12, s99, 6
    v_add_u32 v67, s12, v8
    s_mul_i32 s12, s99, 48
    v_add_u32 v71, s12, v7
    s_mul_i32 s13, s5, 73728
    s_add_u32 s13, s13, 6291456
    s_lshl_b32 s12, s96, 10
    s_add_u32 s64, s12, s13
    s_lshl_b32 s12, s97, 10
    s_add_u32 s65, s12, s13
    s_lshl_b32 s12, s98, 10
    s_add_u32 s66, s12, s13
    s_lshl_b32 s12, s99, 10
    s_add_u32 s67, s12, s13
    s_cmp_lt_u32 s3, 4
    s_cmov_b32 s67, s66
    s_mov_b32 s24, 0
    s_mov_b32 s25, 0xffff0000
    s_mov_b32 s38, 0x05040100
    s_mov_b32 s39, 0x07060302
    s_lshl_b32 s18, s3, 10
    v_cmp_eq_u32_e64 s[76:77], 1, v3
    s_lshl_b32 s12, s3, 11
    s_add_u32 s12, s12, 8192
    v_add_u32 v76, s12, v1
    v_xor_b32 v77, 64, v76
    v_lshrrev_b32 v6, 1, v4
    v_lshrrev_b32 v7, 8, v1
    v_xor_b32 v6, v6, v7
    v_lshlrev_b32 v6, 4, v6
    v_lshl_add_u32 v6, v4, 7, v6
    v_add_u32 v78, s12, v6
    v_xor_b32 v79, 64, v78
    v_lshlrev_b32 v6, 5, v4
    v_lshl_add_u32 v6, v7, 3, v6
    v_add_u32 v90, s12, v6
    v_mov_b32 v28, 0x3f803f80
    v_mov_b32 v29, 0x3f803f80
    v_mov_b32 v30, 0x3f803f80
    v_mov_b32 v31, 0x3f803f80
    v_bfe_u32 v6, v1, 6, 2
    v_lshl_add_u32 v6, v3, 3, v6
    v_lshlrev_b32 v6, 6, v6
    v_bfe_u32 v8, v1, 4, 2
    v_lshl_add_u32 v8, v5, 2, v8
    s_and_b32 s13, s5, 1
    v_add_u32 v8, s13, v8
    v_and_b32 v8, 7, v8
    v_lshl_add_u32 v6, v8, 3, v6
    s_add_u32 s12, s72, 24576
    v_add_u32 v44, s12, v6
    s_add_u32 s12, s73, 24576
    v_add_u32 v45, s12, v6
    s_add_u32 s12, s74, 24576
    v_add_u32 v46, s12, v6
    s_add_u32 s12, s75, 24576
    v_add_u32 v47, s12, v6
    v_lshrrev_b32 v8, 7, v1
    v_mul_u32_u24 v13, 896, v8
    v_lshlrev_b32 v8, 5, v5
    v_and_b32 v9, 0x70, v1
    v_xor_b32 v8, v8, v9
    s_and_b32 s12, s3, 1
    s_lshl_b32 s12, s12, 6
    v_xor_b32 v8, s12, v8
    v_add_u32 v13, v13, v8
    s_lshr_b32 s13, s3, 2
    s_lshl1_add_u32 s12, s8, s13
    s_mul_i32 s17, s12, 50176
    s_lshl_b32 s12, s6, 7
    s_add_u32 s17, s17, s12
    v_mul_u32_u24 v14, 3584, v7
    v_lshlrev_b32 v8, 5, v7
    s_lshl_b32 s13, s13, 7
    v_or_b32 v8, s13, v8
    v_and_b32 v9, 0xf0, v1
    v_xor_b32 v8, v8, v9
    v_add_u32 v14, v14, v8
    s_mul_i32 s16, s7, 7
    s_add_u32 s16, s16, s6
    s_lshl_b32 s16, s16, 8
    s_mul_i32 s12, s8, 14336
    s_add_u32 s16, s16, s12
    s_cmp_eq_u32 s6, 7
    s_cselect_b32 s16, 0x7f000000, s16
    s_cselect_b32 s17, 0x7f000000, s17
    s_mov_b32 s0, s16
    s_mov_b32 s1, 57344
    s_cmp_lt_u32 s9, 28
    s_cbranch_scc0 emd_1
    s_mov_b32 s60, s34
    s_mov_b32 s61, s35
    s_mov_b32 s62, 2408448
    s_mul_i32 s0, s3, 43008
    s_lshl_b32 s1, s9, 7
    s_add_u32 s0, s0, s1
    s_add_u32 s0, s0, 1792
    s_mov_b32 s1, 344064
    v_lshrrev_b32 v8, 7, v1
    v_mul_u32_u24 v14, 5376, v8
    v_lshrrev_b32 v8, 8, v1
    v_lshlrev_b32 v8, 5, v8
    v_and_b32 v9, 0x70, v1
    v_xor_b32 v8, v8, v9
    v_add_u32 v14, v14, v8
emd_1:
    v_min_u32 v91, 880, v1
    v_lshrrev_b32 v8, 3, v91
    s_mul_i32 s12, s3, 112
    v_add_u32 v8, s12, v8
    v_lshrrev_b32 v9, 4, v8
    v_mul_u32_u24 v9, 48, v9
    v_and_b32 v10, 15, v8
    v_lshl_add_u32 v88, v10, 1, v9
    v_lshlrev_b32 v89, 2, v8
    v_bfe_u32 v4, v1, 6, 2
    v_bfe_u32 v5, v1, 8, 1
    v_lshl_add_u32 v6, v3, 2, v4
    v_lshlrev_b32 v10, 8, v6
    v_lshl_add_u32 v10, v5, 12, v10
    v_lshl_add_u32 v4, v5, 2, v4
    v_xor_b32 v4, s3, v4
    v_lshl_add_u32 v10, v4, 5, v10
    v_bfe_u32 v4, v1, 4, 2
    v_lshl_add_u32 v10, v4, 3, v10
    v_add_u32 v11, 102400, v10
    v_add_u32 v10, 40960, v10
    v_bfe_u32 v4, v1, 4, 4
    v_min_u32 v4, 13, v4
    v_lshlrev_b32 v4, 7, v4
    v_mul_u32_u24 v167, 3584, v7
    v_add_u32 v167, v167, v4
    s_cmp_lt_u32 s3, 4
    s_cbranch_scc1 xdone
    s_cmp_lt_u32 s9, 28
    s_cbranch_scc0 xhi
    s_barrier
xhi:
    s_add_u32 s13, s101, s83
    buffer_load_dwordx4 v[200:203], v16, s[48:51], s13 offen
    buffer_load_dwordx4 v[204:207], v17, s[48:51], s13 offen
    s_add_u32 s83, s83, 128
    s_cmp_eq_u32 s83, 896
    s_cselect_b32 s83, 0, s83
    s_add_u32 s13, s101, s83
    buffer_load_dwordx4 v[208:211], v16, s[48:51], s13 offen
    buffer_load_dwordx4 v[212:215], v17, s[48:51], s13 offen
    s_add_u32 s83, s83, 128
    s_cmp_eq_u32 s83, 896
    s_cselect_b32 s83, 0, s83
    s_add_u32 s13, s101, s83
    buffer_load_dwordx4 v[216:219], v16, s[48:51], s13 offen
    buffer_load_dwordx4 v[220:223], v17, s[48:51], s13 offen
    s_add_u32 s83, s83, 128
    s_cmp_eq_u32 s83, 896
    s_cselect_b32 s83, 0, s83
    s_add_u32 s13, s101, s83
    buffer_load_dwordx4 v[224:227], v16, s[48:51], s13 offen
    buffer_load_dwordx4 v[228:231], v17, s[48:51], s13 offen
    s_add_u32 s83, s83, 128
    s_cmp_eq_u32 s83, 896
    s_cselect_b32 s83, 0, s83
    s_add_u32 s13, s101, s83
    buffer_load_dwordx4 v[232:235], v16, s[48:51], s13 offen
    buffer_load_dwordx4 v[236:239], v17, s[48:51], s13 offen
    s_add_u32 s83, s83, 128
    s_cmp_eq_u32 s83, 896
    s_cselect_b32 s83, 0, s83
    s_add_u32 s13, s101, s83
    buffer_load_dwordx4 v[240:243], v16, s[48:51], s13 offen
    buffer_load_dwordx4 v[244:247], v17, s[48:51], s13 offen
    s_add_u32 s83, s83, 128
    s_cmp_eq_u32 s83, 896
    s_cselect_b32 s83, 0, s83
    s_add_u32 s13, s101, s83
    buffer_load_dwordx4 v[248:251], v16, s[48:51], s13 offen
    buffer_load_dwordx4 v[252:255], v17, s[48:51], s13 offen
    s_add_u32 m0, s72, 23680
    s_nop 0
    buffer_load_dwordx4 v12, s[52:55], s78 offen offset:896 lds
xdone:
    s_add_u32 m0, s73, 23680
    s_nop 0
    buffer_load_dwordx4 v12, s[52:55], s79 offen offset:896 lds
    s_add_u32 m0, s74, 23680
    s_nop 0
    buffer_load_dwordx4 v12, s[52:55], s80 offen offset:896 lds
    s_cmp_ge_u32 s3, 4
    s_cbranch_scc0 ehi_2
    s_add_u32 m0, s75, 23680
    s_nop 0
    buffer_load_dwordx4 v12, s[52:55], s81 offen offset:896 lds
    s_cmp_eq_u32 s3, 7
    s_cbranch_scc0 ew7_3
    v_lshrrev_b32 v6, 6, v1
    v_bfe_u32 v7, v1, 4, 2
    v_mul_u32_u24 v8, 56, v6
    v_lshl_add_u32 v8, v7, 4, v8
    v_add_u32 v9, 896, v8
    v_mov_b32 v6, 0x7f000000
    v_cmp_gt_u32 vcc, 768, v1
    s_nop 1
    v_cndmask_b32 v9, v6, v9, vcc
    s_mul_i32 s12, s5, 1568
    s_mov_b32 m0, 6144
    s_nop 0
    buffer_load_dwordx4 v8, s[68:71], s12 offen lds
    s_mov_b32 m0, 7168
    s_nop 0
    buffer_load_dwordx4 v9, s[68:71], s12 offen lds
ew7_3:
ehi_2:
    s_cmp_lt_u32 s3, 4
    s_cbranch_scc0 elo_4
    s_cmp_lt_u32 s9, 28
    s_cbranch_scc1 rawdone
    buffer_store_dwordx4 v[124:127], v1, s[44:47], s42 offen sc1
    v_lshrrev_b32 v9, 1, v1
    s_mov_b64 exec, 0xffffffff
    buffer_store_dwordx2 v[124:125], v9, s[44:47], s43 offen sc1
    s_mov_b64 exec, -1
    s_add_u32 m0, s75, 24576
    s_nop 0
    buffer_load_dwordx4 v12, s[52:55], s81 offen lds
rawdone:
elo_4:
    s_waitcnt lgkmcnt(0)
    s_add_u32 s10, s10, 1
    s_waitcnt vmcnt(16)
    ds_write_b128 v76, v[200:203]
    s_waitcnt vmcnt(15)
    ds_write_b128 v77, v[204:207] offset:1024
    ds_read_b128 v[200:203], v78
    ds_read_b128 v[204:207], v79
    s_waitcnt vmcnt(14)
    ds_write_b128 v76, v[208:211]
    s_waitcnt vmcnt(13)
    ds_write_b128 v77, v[212:215] offset:1024
    ds_read_b128 v[208:211], v78
    ds_read_b128 v[212:215], v79
    s_waitcnt lgkmcnt(5)
    v_mfma_f32_16x16x32_bf16 v[80:83], v[28:31], v[200:203], 0
    v_mfma_f32_16x16x32_bf16 v[84:87], v[200:203], v[200:203], 0
    s_waitcnt lgkmcnt(4)
    v_mfma_f32_16x16x32_bf16 v[80:83], v[28:31], v[204:207], v[80:83]
    v_mfma_f32_16x16x32_bf16 v[84:87], v[204:207], v[204:207], v[84:87]
    s_waitcnt vmcnt(12)
    ds_write_b128 v76, v[216:219]
    s_waitcnt vmcnt(11)
    ds_write_b128 v77, v[220:223] offset:1024
    ds_read_b128 v[216:219], v78
    ds_read_b128 v[220:223], v79
    s_waitcnt lgkmcnt(5)
    v_mfma_f32_16x16x32_bf16 v[80:83], v[28:31], v[208:211], v[80:83]
    v_mfma_f32_16x16x32_bf16 v[84:87], v[208:211], v[208:211], v[84:87]
    s_waitcnt lgkmcnt(4)
    v_mfma_f32_16x16x32_bf16 v[80:83], v[28:31], v[212:215], v[80:83]
    v_mfma_f32_16x16x32_bf16 v[84:87], v[212:215], v[212:215], v[84:87]
    s_waitcnt vmcnt(10)
    ds_write_b128 v76, v[224:227]
    s_waitcnt vmcnt(9)
    ds_write_b128 v77, v[228:231] offset:1024
    ds_read_b128 v[224:227], v78
    ds_read_b128 v[228:231], v79
    s_waitcnt lgkmcnt(5)
    v_mfma_f32_16x16x32_bf16 v[80:83], v[28:31], v[216:219], v[80:83]
    v_mfma_f32_16x16x32_bf16 v[84:87], v[216:219], v[216:219], v[84:87]
    s_waitcnt lgkmcnt(4)
    v_mfma_f32_16x16x32_bf16 v[80:83], v[28:31], v[220:223], v[80:83]
    v_mfma_f32_16x16x32_bf16 v[84:87], v[220:223], v[220:223], v[84:87]
    s_waitcnt vmcnt(8)
    ds_write_b128 v76, v[232:235]
    s_waitcnt vmcnt(7)
    ds_write_b128 v77, v[236:239] offset:1024
    ds_read_b128 v[232:235], v78
    ds_read_b128 v[236:239], v79
    s_waitcnt lgkmcnt(5)
    v_mfma_f32_16x16x32_bf16 v[80:83], v[28:31], v[224:227], v[80:83]
    v_mfma_f32_16x16x32_bf16 v[84:87], v[224:227], v[224:227], v[84:87]
    s_waitcnt lgkmcnt(4)
    v_mfma_f32_16x16x32_bf16 v[80:83], v[28:31], v[228:231], v[80:83]
    v_mfma_f32_16x16x32_bf16 v[84:87], v[228:231], v[228:231], v[84:87]
    s_waitcnt vmcnt(6)
    ds_write_b128 v76, v[240:243]
    s_waitcnt vmcnt(5)
    ds_write_b128 v77, v[244:247] offset:1024
    ds_read_b128 v[240:243], v78
    ds_read_b128 v[244:247], v79
    s_waitcnt lgkmcnt(5)
    v_mfma_f32_16x16x32_bf16 v[80:83], v[28:31], v[232:235], v[80:83]
    v_mfma_f32_16x16x32_bf16 v[84:87], v[232:235], v[232:235], v[84:87]
    s_waitcnt lgkmcnt(4)
    v_mfma_f32_16x16x32_bf16 v[80:83], v[28:31], v[236:239], v[80:83]
    v_mfma_f32_16x16x32_bf16 v[84:87], v[236:239], v[236:239], v[84:87]
    s_waitcnt vmcnt(4)
    ds_write_b128 v76, v[248:251]
    s_waitcnt vmcnt(3)
    ds_write_b128 v77, v[252:255] offset:1024
    ds_read_b128 v[248:251], v78
    ds_read_b128 v[252:255], v79
    s_waitcnt lgkmcnt(5)
    v_mfma_f32_16x16x32_bf16 v[80:83], v[28:31], v[240:243], v[80:83]
    v_mfma_f32_16x16x32_bf16 v[84:87], v[240:243], v[240:243], v[84:87]
    s_waitcnt lgkmcnt(4)
    v_mfma_f32_16x16x32_bf16 v[80:83], v[28:31], v[244:247], v[80:83]
    v_mfma_f32_16x16x32_bf16 v[84:87], v[244:247], v[244:247], v[84:87]
    s_waitcnt lgkmcnt(1)
    v_mfma_f32_16x16x32_bf16 v[80:83], v[28:31], v[248:251], v[80:83]
    v_mfma_f32_16x16x32_bf16 v[84:87], v[248:251], v[248:251], v[84:87]
    s_waitcnt lgkmcnt(0)
    v_mfma_f32_16x16x32_bf16 v[80:83], v[28:31], v[252:255], v[80:83]
    v_mfma_f32_16x16x32_bf16 v[84:87], v[252:255], v[252:255], v[84:87]
    v_mov_b32 v17, v90
    v_and_b32 v16, 0x300, v1
    v_add_u32 v16, v16, v1
    v_add_u32 v16, 24576, v16
    v_mov_b32 v20, 0
    v_mov_b32 v21, 0
    v_mov_b32 v22, 0
    v_mov_b32 v23, 0
    v_mov_b32 v24, 0
    v_mov_b32 v25, 0
    v_mov_b32 v26, 0
    v_mov_b32 v27, 0
    v_mov_b32 v43, 0
    v_mov_b32 v4, 0
    v_bfe_u32 v5, v1, 8, 1
    v_lshlrev_b32 v5, 2, v5
    v_add_u32 v5, 1, v5
    v_bfe_u32 v6, v1, 4, 4
    v_cmp_eq_u32 vcc, v5, v6
    s_mov_b32 exec_lo, 0x00100001
    s_mov_b32 exec_hi, 0x10000100
    v_mov_b32 v4, v84
    s_lshl_b64 exec, exec, 1
    v_mov_b32 v4, v85
    s_lshl_b64 exec, exec, 1
    v_mov_b32 v4, v86
    s_lshl_b64 exec, exec, 1
    v_mov_b32 v4, v87
    s_mov_b64 exec, -1
    v_cndmask_b32 v28, 0, v28, vcc
    v_cndmask_b32 v29, 0, v29, vcc
    v_cndmask_b32 v30, 0, v30, vcc
    v_cndmask_b32 v31, 0, v31, vcc
    v_mov_b32 v5, v4
    s_nop 1
    v_permlane32_swap_b32 v4, v5
    v_add_f32 v4, v4, v5
    v_mov_b32 v5, v4
    s_nop 1
    v_permlane16_swap_b32 v4, v5
    v_add_f32 v4, v4, v5
    v_mul_f32 v6, 0xbb124925, v80
    v_mul_f32 v4, 0x3b124925, v4
    v_fma_f32 v4, -v6, v6, v4
    v_max_f32 v4, 0, v4
    v_add_f32 v4, 0x3727c5ac, v4
    v_rsq_f32 v19, v4
    v_sqrt_f32 v4, v4
    v_mul_f32 v18, 0x3fb8aa3b, v19
    v_cvt_pk_bf16_f32 v5, v6, v4
    v_lshlrev_b32 v7, 16, v5
    v_and_b32 v8, 0xffff0000, v5
    v_sub_f32 v6, v6, v7
    v_sub_f32 v4, v4, v8
    v_cvt_pk_bf16_f32 v4, v6, v4
    v_and_b32 v6, 0xffff, v4
    s_mov_b64 exec, 0xffff
    v_perm_b32 v20, v5, v5, s38
    v_or_b32 v21, v6, v8
    v_perm_b32 v22, v4, v5, s39
    s_mov_b64 exec, 0xffff0000
    v_perm_b32 v24, v5, v5, s38
    v_or_b32 v25, v6, v8
    v_perm_b32 v26, v4, v5, s39
    s_mov_b64 exec, -1
    s_cmp_lt_u32 s3, 4
    s_cbranch_scc0 elo_5
    s_mul_i32 s15, s3, 896
    s_add_u32 s14, s15, 90112
    s_add_u32 s15, s15, 65536
    buffer_load_dwordx4 v[72:75], v91, s[44:47], s15 offen sc1
    buffer_load_dwordx4 v[144:147], v91, s[44:47], s15 offen offset:3584 sc1
    buffer_load_dwordx4 v[148:151], v91, s[44:47], s14 offen sc1
    buffer_load_dwordx4 v[152:155], v91, s[44:47], s14 offen offset:3584 sc1
    v_mov_b32 v5, s10
    s_lshl_b32 s12, s5, 4
    s_add_u32 s12, s12, s4
    s_lshl2_add_u32 s12, s12, s3
    s_lshl_b32 s12, s12, 7
    s_add_u32 s12, s12, 262144
    s_waitcnt vmcnt(4)
    s_mov_b64 exec, 1
    buffer_store_dword v5, v1, s[44:47], s12 offen sc1
    s_mov_b64 exec, -1
    s_cmp_lt_u32 s9, 28
    s_cbranch_scc0 emdl_6
    v_lshlrev_b32 v164, 16, v164
    v_mul_f32 v165, 0xbfb8aa3b, v164
    v_exp_f32 v165, v165
    v_min_u32 v8, 880, v1
    v_lshrrev_b32 v8, 4, v8
    v_add_f32 v165, 1.0, v165
    v_rcp_f32 v165, v165
    s_mul_i32 s12, s3, 56
    v_add_u32 v8, s12, v8
    v_lshrrev_b32 v9, 1, v8
    v_mul_f32 v164, v164, v165
    v_xor_b32 v9, v9, v8
    v_and_b32 v9, 4, v9
    v_mul_u32_u24 v9, 3, v9
    v_xor_b32 v8, v8, v9
    v_cvt_pk_bf16_f32 v164, v164, 0
    s_mul_i32 s12, s7, 448
    s_add_u32 s13, s12, 162816
    s_sub_u32 s12, 163264, s12
    v_lshl_add_u32 v9, v8, 1, s13
    v_lshl_add_u32 v8, v8, 1, s12
    ds_write_b16 v9, v163
    ds_write_b16 v8, v164
emdl_6:
    v_mov_b32 v92, 0
    v_mov_b32 v93, 0
    v_mov_b32 v94, 0
    v_mov_b32 v95, 0
    v_min_u32 v6, 27, v2
    v_mul_u32_u24 v6, 48, v6
    ds_write_b128 v6, v[92:95] offset:1824
    ds_read_b64_tr_b16 v[92:93], v44 offset:0
    ds_read_b64_tr_b16 v[94:95], v44 offset:256
    ds_read_b64_tr_b16 v[96:97], v45 offset:0
    ds_read_b64_tr_b16 v[98:99], v45 offset:256
    ds_read_b64_tr_b16 v[100:101], v46 offset:0
    ds_read_b64_tr_b16 v[102:103], v46 offset:256
    ds_read_b64_tr_b16 v[104:105], v47 offset:0
    ds_read_b64_tr_b16 v[106:107], v47 offset:256
    s_waitcnt vmcnt(1)
pc_7:
    v_xor_b32 v4, v73, v5
    v_bitop3_b32 v4, v4, v75, v5 bitop3:0xf6
    v_bitop3_b32 v4, v4, v145, v5 bitop3:0xf6
    v_bitop3_b32 v4, v4, v147, v5 bitop3:0xf6
    v_bitop3_b32 v4, v4, v149, v5 bitop3:0xf6
    v_bitop3_b32 v4, v4, v151, v5 bitop3:0xf6
    v_bitop3_b32 v4, v4, v153, v5 bitop3:0xf6
    v_bitop3_b32 v4, v4, v155, v5 bitop3:0xf6
    v_cmp_ne_u32 vcc, 0, v4
    s_cbranch_vccz pd_8
    s_cmp_eq_u32 s11, 0
    s_cbranch_scc1 pd_8
    s_sub_u32 s11, s11, 1
    buffer_load_dwordx4 v[72:75], v91, s[44:47], s15 offen sc1
    buffer_load_dwordx4 v[144:147], v91, s[44:47], s15 offen offset:3584 sc1
    buffer_load_dwordx4 v[148:151], v91, s[44:47], s14 offen sc1
    buffer_load_dwordx4 v[152:155], v91, s[44:47], s14 offen offset:3584 sc1
    s_waitcnt vmcnt(0)
    s_branch pc_7
pd_8:
    v_add_f32 v144, v144, v152
    v_add_f32 v72, v72, v148
    v_add_f32 v146, v146, v154
    v_add_f32 v74, v74, v150
    v_cvt_pk_bf16_f32 v144, 0, v144
    v_cvt_pk_bf16_f32 v146, 0, v146
    v_cvt_pk_bf16_f32 v73, v72, v74
    v_add_f32 v144, 1.0, v144
    v_add_f32 v146, 1.0, v146
    v_cvt_pk_bf16_f32 v145, v144, 0
    v_cvt_pk_bf16_f32 v146, 0, v146
    ds_write_b32 v88, v73 offset:1792
    ds_write2_b32 v89, v145, v146 offset0:0 offset1:1
    ds_read_b128 v[140:143], v71 offset:1792
    ds_read_b128 v[192:195], v67 offset:0
    ds_read_b128 v[196:199], v67 offset:16
    s_waitcnt lgkmcnt(2)
    v_mfma_f32_16x16x32_bf16 v[88:91], v[140:143], v[104:107], 0
    s_waitcnt lgkmcnt(1)
    v_dot2_f32_bf16 v108, v104, v192, 0
    v_dot2_f32_bf16 v109, v104, v193, 0
    v_dot2_f32_bf16 v110, v105, v194, 0
    v_dot2_f32_bf16 v111, v105, v195, 0
    s_waitcnt lgkmcnt(0)
    v_dot2_f32_bf16 v112, v106, v196, 0
    v_dot2_f32_bf16 v113, v106, v197, 0
    v_dot2_f32_bf16 v114, v107, v198, 0
    v_dot2_f32_bf16 v115, v107, v199, 0
    v_cvt_pk_bf16_f32 v104, v108, v109
    v_cvt_pk_bf16_f32 v105, v110, v111
    v_cvt_pk_bf16_f32 v106, v112, v113
    v_cvt_pk_bf16_f32 v107, v114, v115
    s_nop 1
    v_mfma_f32_16x16x32_bf16 v[88:91], v[28:31], v[104:107], v[88:91]
    buffer_store_dwordx4 v[104:107], v1, s[44:47], s42 offen sc1
    v_lshrrev_b32 v9, 1, v1
    s_mov_b64 exec, 0xffffffff
    s_nop 4
    buffer_store_dwordx2 v[88:89], v9, s[44:47], s43 offen sc1
    s_mov_b64 exec, -1
elo_5:
    s_cmp_ge_u32 s3, 4
    s_cbranch_scc0 ehi_9
    v_and_b32 v9, 0x1f0, v1
    v_lshl_add_u32 v9, v3, 15, v9
    s_lshl_b32 s12, s4, 9
    s_add_u32 s12, s12, s20
    s_sub_u32 s12, s12, 32768
    buffer_store_dwordx4 v[124:127], v9, s[44:47], s12 offen sc1
    s_not_b64 exec, s[24:25]
    buffer_store_dwordx4 v[124:127], v1, s[44:47], s21 offen sc1
    s_mov_b64 exec, s[24:25]
    buffer_store_dwordx2 v[124:125], v1, s[44:47], s22 offen sc1
    s_mov_b64 exec, -1
    s_bitcmp1_b32 s100, 2
    s_mov_b32 s14, -57344
    s_cmov_b32 s14, 57344
    s_add_u32 s12, s21, s14
    s_add_u32 s13, s22, s14
    s_not_b64 exec, s[24:25]
    buffer_store_dwordx4 v[124:127], v1, s[44:47], s12 offen sc1
    s_mov_b64 exec, s[24:25]
    buffer_store_dwordx2 v[124:125], v1, s[44:47], s13 offen sc1
    s_mov_b64 exec, -1
    s_mov_b32 s68, s34
    s_mov_b32 s69, s35
    s_mov_b32 s70, 0x24c000
    s_mov_b32 s71, 0x20000
    v_mul_u32_u24 v9, 336, v1
    s_mul_i32 s12, s8, 86016
    s_lshl_b32 s13, s9, 7
    s_add_u32 s12, s12, s13
    s_add_u32 s12, s12, 2066176
    s_cmp_ge_u32 s9, 28
    s_cmov_b32 s12, 0x7f000000
    s_mov_b64 exec, 0xffff
    buffer_load_dword v166, v9, s[68:71], s12 offen
    s_mov_b64 exec, -1
    s_waitcnt vmcnt(6)
    ds_read_b64_tr_b16 v[92:93], v44 offset:0
    ds_read_b64_tr_b16 v[94:95], v44 offset:256
    ds_read_b64_tr_b16 v[96:97], v45 offset:0
    ds_read_b64_tr_b16 v[98:99], v45 offset:256
    ds_read_b64_tr_b16 v[100:101], v46 offset:0
    ds_read_b64_tr_b16 v[102:103], v46 offset:256
    ds_read_b64_tr_b16 v[104:105], v47 offset:0
    ds_read_b64_tr_b16 v[106:107], v47 offset:256
ehi_9:
    s_waitcnt lgkmcnt(0)
    s_barrier
    s_cmp_eq_u32 s3, 4
    s_cbranch_scc0 ew4_10
    v_min_u32 v9, 880, v1
    v_lshlrev_b32 v9, 3, v9
    s_lshl_b32 s12, s5, 13
    s_add_u32 s12, s12, 262144
    buffer_load_dword v164, v9, s[44:47], s12 offen sc1
ew4_10:
    ds_read_b128 v[128:131], v68 offset:1792
    ds_read_b128 v[168:171], v64 offset:0
    ds_read_b128 v[172:175], v64 offset:16
    ds_read_b128 v[132:135], v69 offset:1792
    ds_read_b128 v[176:179], v65 offset:0
    ds_read_b128 v[180:183], v65 offset:16
    ds_read_b128 v[136:139], v70 offset:1792
    ds_read_b128 v[184:187], v66 offset:0
    ds_read_b128 v[188:191], v66 offset:16
    s_cmp_ge_u32 s3, 4
    s_cbranch_scc0 ehi_11
    ds_read_b128 v[140:143], v71 offset:1792
    ds_read_b128 v[192:195], v67 offset:0
    ds_read_b128 v[196:199], v67 offset:16
ehi_11:
    v_lshrrev_b32 v4, 6, v1
    v_lshlrev_b32 v4, 6, v4
    v_bfe_u32 v5, v1, 4, 2
    v_lshl_add_u32 v4, v5, 3, v4
    ds_read_b64_tr_b16 v[32:33], v4 offset:6144
    ds_read_b64_tr_b16 v[34:35], v4 offset:7168
    ds_read_b64_tr_b16 v[36:37], v4 offset:6176
    ds_read_b64_tr_b16 v[38:39], v4 offset:7200
    s_waitcnt lgkmcnt(12)
    v_mfma_f32_16x16x32_bf16 v[88:91], v[128:131], v[92:95], 0
    s_waitcnt lgkmcnt(11)
    v_dot2_f32_bf16 v108, v92, v168, 0
    v_dot2_f32_bf16 v109, v92, v169, 0
    v_dot2_f32_bf16 v110, v93, v170, 0
    v_dot2_f32_bf16 v111, v93, v171, 0
    s_waitcnt lgkmcnt(10)
    v_dot2_f32_bf16 v112, v94, v172, 0
    v_dot2_f32_bf16 v113, v94, v173, 0
    v_dot2_f32_bf16 v114, v95, v174, 0
    v_dot2_f32_bf16 v115, v95, v175, 0
    s_add_u32 s13, s72, 24576
    v_add_u32 v0, s13, v1
    s_add_u32 m0, s18, 110592
    s_nop 0
    buffer_load_dwordx4 v14, s[60:63], s0 offen lds
    s_add_u32 s0, s0, s1
    v_cvt_pk_bf16_f32 v92, v108, v109
    v_cvt_pk_bf16_f32 v93, v110, v111
    v_cvt_pk_bf16_f32 v94, v112, v113
    v_cvt_pk_bf16_f32 v95, v114, v115
    ds_write_b128 v0, v[92:95]
    s_nop 0
    v_mfma_f32_16x16x32_bf16 v[88:91], v[28:31], v[92:95], v[88:91]
    s_add_u32 m0, s18, 118784
    s_nop 0
    buffer_load_dwordx4 v14, s[60:63], s0 offen lds
    s_add_u32 s0, s0, s1
    s_waitcnt lgkmcnt(10)
    v_mfma_f32_16x16x32_bf16 v[88:91], v[132:135], v[96:99], v[88:91]
    s_waitcnt lgkmcnt(9)
    v_dot2_f32_bf16 v108, v96, v176, 0
    v_dot2_f32_bf16 v109, v96, v177, 0
    v_dot2_f32_bf16 v110, v97, v178, 0
    v_dot2_f32_bf16 v111, v97, v179, 0
    s_waitcnt lgkmcnt(8)
    v_dot2_f32_bf16 v112, v98, v180, 0
    v_dot2_f32_bf16 v113, v98, v181, 0
    v_dot2_f32_bf16 v114, v99, v182, 0
    v_dot2_f32_bf16 v115, v99, v183, 0
    s_add_u32 s13, s73, 24576
    v_add_u32 v0, s13, v1
    s_add_u32 m0, s18, 126976
    s_nop 0
    buffer_load_dwordx4 v14, s[60:63], s0 offen lds
    s_add_u32 s0, s0, s1
    v_cvt_pk_bf16_f32 v96, v108, v109
    v_cvt_pk_bf16_f32 v97, v110, v111
    v_cvt_pk_bf16_f32 v98, v112, v113
    v_cvt_pk_bf16_f32 v99, v114, v115
    ds_write_b128 v0, v[96:99]
    s_nop 0
    v_mfma_f32_16x16x32_bf16 v[88:91], v[28:31], v[96:99], v[88:91]
    s_cmp_lt_u32 s3, 4
    s_cbranch_scc0 elo_12
    s_add_u32 m0, s18, 135168
    s_nop 0
    buffer_load_dwordx4 v14, s[60:63], s0 offen lds
    s_add_u32 s0, s0, s1
elo_12:
    s_waitcnt lgkmcnt(8)
    v_mfma_f32_16x16x32_bf16 v[88:91], v[136:139], v[100:103], v[88:91]
    s_waitcnt lgkmcnt(7)
    v_dot2_f32_bf16 v108, v100, v184, 0
    v_dot2_f32_bf16 v109, v100, v185, 0
    v_dot2_f32_bf16 v110, v101, v186, 0
    v_dot2_f32_bf16 v111, v101, v187, 0
    s_waitcnt lgkmcnt(6)
    v_dot2_f32_bf16 v112, v102, v188, 0
    v_dot2_f32_bf16 v113, v102, v189, 0
    v_dot2_f32_bf16 v114, v103, v190, 0
    v_dot2_f32_bf16 v115, v103, v191, 0
    s_add_u32 s13, s74, 24576
    v_add_u32 v0, s13, v1
    s_cmp_lt_u32 s3, 4
    s_cbranch_scc0 elo_13
    s_add_u32 m0, s18, 143360
    s_nop 0
    buffer_load_dwordx4 v14, s[60:63], s0 offen lds
    s_add_u32 s0, s0, s1
elo_13:
    v_cvt_pk_bf16_f32 v100, v108, v109
    v_cvt_pk_bf16_f32 v101, v110, v111
    v_cvt_pk_bf16_f32 v102, v112, v113
    v_cvt_pk_bf16_f32 v103, v114, v115
    ds_write_b128 v0, v[100:103]
    s_nop 0
    v_mfma_f32_16x16x32_bf16 v[88:91], v[28:31], v[100:103], v[88:91]
    s_cmp_lt_u32 s3, 4
    s_cbranch_scc0 elo_14
    s_add_u32 m0, s18, 151552
    s_nop 0
    buffer_load_dwordx4 v14, s[60:63], s0 offen lds
    s_add_u32 s0, s0, s1
elo_14:
    s_cmp_ge_u32 s3, 4
    s_cbranch_scc0 ehi_15
    s_waitcnt lgkmcnt(9)
    v_mfma_f32_16x16x32_bf16 v[88:91], v[140:143], v[104:107], v[88:91]
    s_waitcnt lgkmcnt(8)
    v_dot2_f32_bf16 v108, v104, v192, 0
    v_dot2_f32_bf16 v109, v104, v193, 0
    v_dot2_f32_bf16 v110, v105, v194, 0
    v_dot2_f32_bf16 v111, v105, v195, 0
    s_waitcnt lgkmcnt(7)
    v_dot2_f32_bf16 v112, v106, v196, 0
    v_dot2_f32_bf16 v113, v106, v197, 0
    v_dot2_f32_bf16 v114, v107, v198, 0
    v_dot2_f32_bf16 v115, v107, v199, 0
    s_add_u32 s13, s75, 24576
    v_add_u32 v0, s13, v1
    v_cvt_pk_bf16_f32 v104, v108, v109
    v_cvt_pk_bf16_f32 v105, v110, v111
    v_cvt_pk_bf16_f32 v106, v112, v113
    v_cvt_pk_bf16_f32 v107, v114, v115
    ds_write_b128 v0, v[104:107]
    s_nop 0
    v_mfma_f32_16x16x32_bf16 v[88:91], v[28:31], v[104:107], v[88:91]
ehi_15:
    s_cmp_lt_u32 s3, 4
    s_cmov_b32 s75, s74
    s_lshl_b32 s13, s3, 8
    v_lshrrev_b32 v0, 1, v1
    v_add_u32 v0, s13, v0
    s_mov_b64 exec, 0xffffffff
    s_nop 1
    ds_write_b64 v0, v[88:89] offset:3136
    s_mov_b64 exec, -1
    s_cmp_eq_u32 s3, 4
    s_cbranch_scc0 ew4_16
    v_mov_b32 v0, s10
    s_waitcnt vmcnt(3)
pc_17:
    v_xor_b32 v9, v164, v0
    v_cmp_ne_u32 vcc, 0, v9
    s_cbranch_vccz pd_18
    s_cmp_eq_u32 s11, 0
    s_cbranch_scc1 pd_18
    s_sub_u32 s11, s11, 1
    v_min_u32 v9, 880, v1
    v_lshlrev_b32 v9, 3, v9
    s_lshl_b32 s12, s5, 13
    s_add_u32 s12, s12, 262144
    buffer_load_dword v164, v9, s[44:47], s12 offen sc1
    s_waitcnt vmcnt(0)
    s_branch pc_17
pd_18:
ew4_16:
    s_cmp_ge_u32 s3, 4
    s_cbranch_scc0 ehi_19
    s_waitcnt vmcnt(4)
ehi_19:
    s_waitcnt lgkmcnt(0)
    s_barrier
    s_setprio 0
    s_cmp_lt_u32 s3, 4
    s_cbranch_scc1 pr_20
    s_setprio 1
pr_20:
    s_cmp_eq_u32 s3, 7
    s_cbranch_scc0 ew7_21
    v_mov_b32 v9, s10
    s_lshl_b32 s12, s5, 4
    s_add_u32 s12, s12, s4
    s_lshl_b32 s12, s12, 7
    s_add_u32 s12, s12, 131072
    s_mov_b64 exec, 1
    buffer_store_dword v9, v1, s[44:47], s12 offen sc1
    s_mov_b64 exec, -1
ew7_21:
    ds_read_b128 v[64:67], v16 offset:0
    ds_read_b128 v[68:71], v16 offset:256
    ds_read_b128 v[72:75], v16 offset:2048
    ds_read_b128 v[76:79], v16 offset:2304
    ds_read_b128 v[80:83], v16 offset:4096
    v_lshlrev_b32 v0, 3, v2
    v_add_u32 v0, 3136, v0
    ds_read2_b64 v[92:95], v0 offset0:0 offset1:32
    ds_read2_b64 v[96:99], v0 offset0:64 offset1:96
    ds_read2_b64 v[100:103], v0 offset0:128 offset1:160
    ds_read2_b64 v[104:107], v0 offset0:192 offset1:224
    s_waitcnt lgkmcnt(8)
    v_mfma_f32_16x16x32_bf16 v[48:51], v[64:67], v[200:203], 0
    s_waitcnt lgkmcnt(7)
    v_mfma_f32_16x16x32_bf16 v[52:55], v[68:71], v[200:203], 0
    ds_read_b128 v[84:87], v16 offset:4352
    s_waitcnt lgkmcnt(4)
    v_pk_add_f32 v[92:93], v[92:93], v[94:95]
    s_waitcnt lgkmcnt(3)
    v_pk_add_f32 v[96:97], v[96:97], v[98:99]
    s_waitcnt lgkmcnt(2)
    v_pk_add_f32 v[100:101], v[100:101], v[102:103]
    s_waitcnt lgkmcnt(1)
    v_pk_add_f32 v[104:105], v[104:105], v[106:107]
    s_add_u32 m0, s72, 53248
    s_nop 0
    buffer_load_dwordx4 v1, s[44:47], s64 offen sc1 lds
    v_mfma_f32_16x16x32_bf16 v[48:51], v[72:75], v[204:207], v[48:51]
    ds_read_b128 v[64:67], v16 offset:6144
    v_pk_add_f32 v[92:93], v[92:93], v[96:97]
    v_pk_add_f32 v[100:101], v[100:101], v[104:105]
    v_pk_add_f32 v[92:93], v[92:93], v[100:101]
    v_mfma_f32_16x16x32_bf16 v[52:55], v[76:79], v[204:207], v[52:55]
    ds_read_b128 v[68:71], v16 offset:6400
    v_cvt_pk_bf16_f32 v41, v93, v92
    v_lshlrev_b32 v94, 16, v41
    v_and_b32 v95, 0xffff0000, v41
    v_sub_f32 v93, v93, v94
    s_add_u32 m0, s73, 53248
    s_nop 0
    buffer_load_dwordx4 v1, s[44:47], s65 offen sc1 lds
    v_mfma_f32_16x16x32_bf16 v[48:51], v[80:83], v[208:211], v[48:51]
    ds_read_b128 v[72:75], v16 offset:8192
    v_sub_f32 v92, v92, v95
    v_cvt_pk_bf16_f32 v92, v93, v92
    v_perm_b32 v40, v92, v41, s38
    v_perm_b32 v42, v41, v92, s39
    s_waitcnt lgkmcnt(3)
    v_mfma_f32_16x16x32_bf16 v[52:55], v[84:87], v[208:211], v[52:55]
    ds_read_b128 v[76:79], v16 offset:8448
    v_lshrrev_b32 v195, 1, v1
    s_lshr_b32 s12, s3, 2
    s_lshl_b32 s12, s12, 1
    s_and_b32 s13, s3, 1
    s_add_u32 s12, s12, s13
    s_lshl_b32 s12, s12, 9
    v_add_u32 v192, s12, v195
    s_and_b32 s12, s3, 2
    s_lshl_b32 s12, s12, 8
    v_add_u32 v193, s12, v195
    s_lshl_b32 s23, s4, 9
    s_add_u32 s23, s23, s20
    s_add_u32 m0, s74, 53248
    s_nop 0
    buffer_load_dwordx4 v1, s[44:47], s66 offen sc1 lds
    s_waitcnt lgkmcnt(3)
    v_mfma_f32_16x16x32_bf16 v[48:51], v[64:67], v[212:215], v[48:51]
    ds_read_b128 v[80:83], v16 offset:10240
    v_lshrrev_b32 v194, 9, v1
    v_lshl_add_u32 v194, s8, 1, v194
    v_bfe_u32 v196, v1, 5, 3
    v_xor_b32 v194, v194, v196
    s_waitcnt lgkmcnt(3)
    v_mfma_f32_16x16x32_bf16 v[52:55], v[68:71], v[212:215], v[52:55]
    ds_read_b128 v[84:87], v16 offset:10496
    v_and_b32 v196, 0xf0, v1
    v_lshlrev_b32 v196, 3, v196
    v_lshl_add_u32 v194, v194, 4, v196
    v_bfe_u32 v196, v1, 8, 1
    s_add_u32 m0, s75, 53248
    s_nop 0
    buffer_load_dwordx4 v1, s[44:47], s67 offen sc1 lds
    s_waitcnt lgkmcnt(3)
    v_mfma_f32_16x16x32_bf16 v[48:51], v[72:75], v[216:219], v[48:51]
    ds_read_b128 v[64:67], v16 offset:12288
    v_lshl_add_u32 v194, v196, 3, v194
    s_lshr_b32 s12, s3, 2
    s_lshl_b32 s12, s12, 11
    v_add_u32 v194, s12, v194
    s_waitcnt lgkmcnt(3)
    v_mfma_f32_16x16x32_bf16 v[52:55], v[76:79], v[216:219], v[52:55]
    ds_read_b128 v[68:71], v16 offset:12544
    v_and_b32 v195, 0xf0, v1
    v_lshl_add_u32 v195, v3, 8, v195
    v_lshl_add_u32 v195, v196, 3, v195
    s_mul_i32 s12, s5, 73728
    s_add_u32 s12, s12, s18
    s_add_u32 s12, s12, 6348800
    s_cmp_eq_u32 s3, 7
    s_cmov_b32 s12, 0x7f000000
    buffer_load_dwordx4 v[160:163], v1, s[44:47], s12 offen sc1
    s_waitcnt lgkmcnt(3)
    v_mfma_f32_16x16x32_bf16 v[48:51], v[80:83], v[220:223], v[48:51]
    ds_read_b128 v[72:75], v16 offset:14336
    s_waitcnt lgkmcnt(3)
    v_mfma_f32_16x16x32_bf16 v[52:55], v[84:87], v[220:223], v[52:55]
    ds_read_b128 v[76:79], v16 offset:14592
    s_add_u32 m0, s72, 81920
    s_add_u32 s12, s64, 28672
    buffer_load_dwordx4 v1, s[44:47], s12 offen sc1 lds
    s_waitcnt lgkmcnt(3)
    v_mfma_f32_16x16x32_bf16 v[48:51], v[64:67], v[224:227], v[48:51]
    ds_read_b128 v[80:83], v16 offset:16384
    s_waitcnt lgkmcnt(3)
    v_mfma_f32_16x16x32_bf16 v[52:55], v[68:71], v[224:227], v[52:55]
    ds_read_b128 v[84:87], v16 offset:16640
    s_add_u32 m0, s73, 81920
    s_add_u32 s12, s65, 28672
    buffer_load_dwordx4 v1, s[44:47], s12 offen sc1 lds
    s_waitcnt lgkmcnt(3)
    v_mfma_f32_16x16x32_bf16 v[48:51], v[72:75], v[228:231], v[48:51]
    ds_read_b128 v[64:67], v16 offset:18432
    s_setprio 0
    s_waitcnt lgkmcnt(3)
    v_mfma_f32_16x16x32_bf16 v[52:55], v[76:79], v[228:231], v[52:55]
    ds_read_b128 v[68:71], v16 offset:18688
    s_add_u32 m0, s74, 81920
    s_add_u32 s12, s66, 28672
    buffer_load_dwordx4 v1, s[44:47], s12 offen sc1 lds
    s_waitcnt lgkmcnt(3)
    v_mfma_f32_16x16x32_bf16 v[48:51], v[80:83], v[232:235], v[48:51]
    ds_read_b128 v[72:75], v16 offset:20480
    s_waitcnt lgkmcnt(3)
    v_mfma_f32_16x16x32_bf16 v[52:55], v[84:87], v[232:235], v[52:55]
    ds_read_b128 v[76:79], v16 offset:20736
    s_add_u32 m0, s75, 81920
    s_add_u32 s12, s67, 28672
    buffer_load_dwordx4 v1, s[44:47], s12 offen sc1 lds
    s_waitcnt lgkmcnt(3)
    v_mfma_f32_16x16x32_bf16 v[48:51], v[64:67], v[236:239], v[48:51]
    ds_read_b128 v[80:83], v16 offset:22528
    s_waitcnt lgkmcnt(3)
    v_mfma_f32_16x16x32_bf16 v[52:55], v[68:71], v[236:239], v[52:55]
    ds_read_b128 v[84:87], v16 offset:22784
    s_mul_i32 s12, s5, 73728
    s_add_u32 s12, s12, s18
    s_add_u32 s12, s12, 6356992
    s_cmp_eq_u32 s3, 7
    s_cmov_b32 s12, 0x7f000000
    buffer_load_dwordx4 v[168:171], v1, s[44:47], s12 offen sc1
    s_waitcnt lgkmcnt(3)
    v_mfma_f32_16x16x32_bf16 v[48:51], v[72:75], v[240:243], v[48:51]
    ds_read_b128 v[64:67], v16 offset:24576
    s_waitcnt lgkmcnt(3)
    v_mfma_f32_16x16x32_bf16 v[52:55], v[76:79], v[240:243], v[52:55]
    ds_read_b128 v[68:71], v16 offset:24832
    s_cmp_ge_u32 s3, 4
    s_cbranch_scc0 ehi_22
    s_add_u32 m0, s18, 135168
    s_nop 0
    buffer_load_dwordx4 v14, s[60:63], s0 offen lds
    s_add_u32 s0, s0, s1
ehi_22:
    s_waitcnt lgkmcnt(3)
    v_mfma_f32_16x16x32_bf16 v[48:51], v[80:83], v[244:247], v[48:51]
    ds_read_b128 v[72:75], v16 offset:26624
    s_waitcnt lgkmcnt(3)
    v_mfma_f32_16x16x32_bf16 v[52:55], v[84:87], v[244:247], v[52:55]
    ds_read_b128 v[76:79], v16 offset:26880
    s_cmp_ge_u32 s3, 4
    s_cbranch_scc0 ehi_23
    s_add_u32 m0, s18, 143360
    s_nop 0
    buffer_load_dwordx4 v14, s[60:63], s0 offen lds
    s_add_u32 s0, s0, s1
ehi_23:
    s_waitcnt lgkmcnt(3)
    v_mfma_f32_16x16x32_bf16 v[48:51], v[64:67], v[248:251], v[48:51]
    s_waitcnt lgkmcnt(2)
    v_mfma_f32_16x16x32_bf16 v[52:55], v[68:71], v[248:251], v[52:55]
    s_cmp_ge_u32 s3, 4
    s_cbranch_scc0 ehi_24
    s_add_u32 m0, s18, 151552
    s_nop 0
    buffer_load_dwordx4 v14, s[60:63], s0 offen lds
    s_add_u32 s0, s0, s1
ehi_24:
    s_waitcnt lgkmcnt(1)
    v_mfma_f32_16x16x32_bf16 v[48:51], v[72:75], v[252:255], v[48:51]
    s_waitcnt lgkmcnt(0)
    v_mfma_f32_16x16x32_bf16 v[52:55], v[76:79], v[252:255], v[52:55]
    v_mfma_f32_16x16x32_bf16 v[48:51], v[40:43], v[20:23], v[48:51]
    v_mfma_f32_16x16x32_bf16 v[52:55], v[40:43], v[24:27], v[52:55]
    s_nop 6
    v_cvt_pk_bf16_f32 v48, v48, v49
    v_cvt_pk_bf16_f32 v49, v50, v51
    v_cvt_pk_bf16_f32 v50, v52, v53
    v_cvt_pk_bf16_f32 v51, v54, v55
    s_nop 1
    v_mfma_f32_16x16x32_bf16 v[116:119], v[32:35], v[48:51], 0
    v_mfma_f32_16x16x32_bf16 v[120:123], v[36:39], v[48:51], 0
    s_waitcnt vmcnt(5)
    s_add_u32 s13, s72, 53248
    v_add_u32 v0, s13, v1
    ds_read_b32 v156, v0
    s_add_u32 s13, s73, 53248
    v_add_u32 v0, s13, v1
    ds_read_b32 v157, v0
    s_add_u32 s13, s74, 53248
    v_add_u32 v0, s13, v1
    ds_read_b32 v158, v0
    s_add_u32 s13, s75, 53248
    v_add_u32 v0, s13, v1
    ds_read_b32 v159, v0
    s_waitcnt lgkmcnt(3)
    v_max3_u32 v9, v160, v162, v156
    s_waitcnt lgkmcnt(1)
    v_max3_u32 v9, v9, v157, v158
    s_waitcnt lgkmcnt(0)
    v_max_u32 v9, v9, v159
    v_cmp_eq_u32 vcc, -1, v9
    s_cbranch_vccz pd_26
pc_25:
    s_cmp_eq_u32 s11, 0
    s_cbranch_scc1 pd_26
    s_sub_u32 s11, s11, 1
    v_max_u32 v9, v160, v162
    v_cmp_eq_u32 vcc, -1, v9
    s_cbranch_vccz ps_27
    s_mul_i32 s12, s5, 73728
    s_add_u32 s12, s12, s18
    s_add_u32 s12, s12, 6348800
    s_cmp_eq_u32 s3, 7
    s_cmov_b32 s12, 0x7f000000
    buffer_load_dwordx4 v[160:163], v1, s[44:47], s12 offen sc1
ps_27:
    v_cmp_eq_u32 vcc, -1, v156
    s_cbranch_vccz ps_28
    s_add_u32 m0, s72, 53248
    s_nop 0
    buffer_load_dwordx4 v1, s[44:47], s64 offen sc1 lds
ps_28:
    v_cmp_eq_u32 vcc, -1, v157
    s_cbranch_vccz ps_29
    s_add_u32 m0, s73, 53248
    s_nop 0
    buffer_load_dwordx4 v1, s[44:47], s65 offen sc1 lds
ps_29:
    v_cmp_eq_u32 vcc, -1, v158
    s_cbranch_vccz ps_30
    s_add_u32 m0, s74, 53248
    s_nop 0
    buffer_load_dwordx4 v1, s[44:47], s66 offen sc1 lds
ps_30:
    v_cmp_eq_u32 vcc, -1, v159
    s_cbranch_vccz ps_31
    s_add_u32 m0, s75, 53248
    s_nop 0
    buffer_load_dwordx4 v1, s[44:47], s67 offen sc1 lds
ps_31:
    s_waitcnt vmcnt(0)
    s_add_u32 s13, s72, 53248
    v_add_u32 v0, s13, v1
    ds_read_b32 v156, v0
    s_add_u32 s13, s73, 53248
    v_add_u32 v0, s13, v1
    ds_read_b32 v157, v0
    s_add_u32 s13, s74, 53248
    v_add_u32 v0, s13, v1
    ds_read_b32 v158, v0
    s_add_u32 s13, s75, 53248
    v_add_u32 v0, s13, v1
    ds_read_b32 v159, v0
    s_waitcnt lgkmcnt(3)
    v_max3_u32 v9, v160, v162, v156
    s_waitcnt lgkmcnt(1)
    v_max3_u32 v9, v9, v157, v158
    s_waitcnt lgkmcnt(0)
    v_max_u32 v9, v9, v159
    v_cmp_eq_u32 vcc, -1, v9
    s_waitcnt lgkmcnt(0)
    s_cbranch_vccnz pc_25
    s_nop 4
pd_26:
    v_permlane32_swap_b32 v160, v162
    v_permlane32_swap_b32 v161, v163
    v_and_b32 v0, 0xf0, v1
    v_lshrrev_b32 v9, 8, v1
    v_add_f32 v160, v160, v162
    v_add_f32 v161, v161, v163
    v_lshl_add_u32 v0, v9, 2, v0
    s_lshl_b32 s13, s3, 8
    v_permlane16_swap_b32 v160, v161
    v_add_u32 v0, s13, v0
    v_add_f32 v160, v160, v161
    ds_write_b32 v0, v160 offset:6144
    s_waitcnt lgkmcnt(0)
    s_barrier
    ds_read_b128 v[64:67], v16 offset:28672
    ds_read_b128 v[68:71], v16 offset:28928
    ds_read_b128 v[72:75], v16 offset:30720
    ds_read_b128 v[76:79], v16 offset:30976
    ds_read_b128 v[80:83], v16 offset:32768
    v_max3_f32 v4, v116, v117, v118
    v_min3_f32 v5, v116, v117, v118
    v_max3_f32 v6, v120, v121, v122
    v_min3_f32 v7, v120, v121, v122
    v_lshlrev_b32 v0, 3, v2
    v_add_u32 v0, 6144, v0
    ds_read2_b64 v[144:147], v0 offset0:0 offset1:32
    ds_read2_b64 v[148:151], v0 offset0:64 offset1:96
    ds_read2_b64 v[152:155], v0 offset0:128 offset1:160
    ds_read2_b64 v[156:159], v0 offset0:192 offset1:224
    s_waitcnt lgkmcnt(8)
    v_mfma_f32_16x16x32_bf16 v[56:59], v[64:67], v[200:203], 0
    v_max_f32 v4, v4, v119
    v_min_f32 v5, v5, v119
    v_max3_f32 v6, v6, v123, v4
    v_min3_f32 v7, v7, v123, v5
    s_waitcnt lgkmcnt(7)
    v_mfma_f32_16x16x32_bf16 v[60:63], v[68:71], v[200:203], 0
    ds_read_b128 v[84:87], v16 offset:33024
    v_cndmask_b32_e64 v4, v6, v4, s[24:25]
    v_cndmask_b32_e64 v5, -v7, -v5, s[24:25]
    s_waitcnt lgkmcnt(4)
    v_pk_add_f32 v[144:145], v[144:145], v[146:147]
    s_waitcnt lgkmcnt(3)
    v_pk_add_f32 v[148:149], v[148:149], v[150:151]
    s_waitcnt lgkmcnt(2)
    v_pk_add_f32 v[152:153], v[152:153], v[154:155]
    s_waitcnt lgkmcnt(1)
    v_pk_add_f32 v[156:157], v[156:157], v[158:159]
    v_mfma_f32_16x16x32_bf16 v[56:59], v[72:75], v[204:207], v[56:59]
    ds_read_b128 v[64:67], v16 offset:34816
    v_permlane32_swap_b32 v4, v5
    v_max_f32 v4, v4, v5
    v_mov_b32 v5, v4
    v_pk_add_f32 v[144:145], v[144:145], v[148:149]
    v_pk_add_f32 v[152:153], v[152:153], v[156:157]
    v_pk_add_f32 v[144:145], v[144:145], v[152:153]
    v_mfma_f32_16x16x32_bf16 v[60:63], v[76:79], v[204:207], v[60:63]
    ds_read_b128 v[68:71], v16 offset:35072
    v_permlane16_swap_b32 v4, v5
    v_max_f32 v4, v4, v5
    v_mul_f32_e64 v4, v4, -v18
    v_mov_b32 v5, v4
    v_cvt_pk_bf16_f32 v41, v145, v144
    v_lshlrev_b32 v146, 16, v41
    v_and_b32 v147, 0xffff0000, v41
    v_sub_f32 v145, v145, v146
    v_mfma_f32_16x16x32_bf16 v[56:59], v[80:83], v[208:211], v[56:59]
    ds_read_b128 v[72:75], v16 offset:36864
    v_permlane32_swap_b32 v4, v5
    v_mov_b32 v8, 0xff800000
    v_cndmask_b32_e64 v6, v4, v8, s[24:25]
    v_cndmask_b32_e64 v7, v5, v8, s[24:25]
    v_sub_f32 v144, v144, v147
    v_cvt_pk_bf16_f32 v144, v145, v144
    v_perm_b32 v40, v144, v41, s38
    v_perm_b32 v42, v41, v144, s39
    s_waitcnt lgkmcnt(3)
    v_mfma_f32_16x16x32_bf16 v[60:63], v[84:87], v[208:211], v[60:63]
    ds_read_b128 v[76:79], v16 offset:37120
    v_fma_f32 v92, v116, v18, v4
    v_fma_f32 v93, v117, v18, v4
    v_fma_f32 v94, v118, v18, v4
    v_fma_f32 v95, v119, v18, v4
    v_exp_f32 v92, v92
    v_exp_f32 v93, v93
    v_exp_f32 v94, v94
    v_exp_f32 v95, v95
    s_cmp_eq_u32 s3, 4
    s_cbranch_scc0 ew4_32
    v_bfe_u32 v165, v1, 4, 4
    v_lshl_add_u32 v164, v165, 4, s4
    s_lshl_b32 s12, s5, 4
    v_add_u32 v165, s12, v165
    v_cndmask_b32_e64 v165, v165, v164, s[76:77]
    v_lshlrev_b32 v165, 7, v165
    v_add_u32 v165, 131072, v165
    buffer_load_dword v164, v165, s[44:47], 0 offen sc1
ew4_32:
    s_waitcnt lgkmcnt(3)
    v_mfma_f32_16x16x32_bf16 v[56:59], v[64:67], v[212:215], v[56:59]
    ds_read_b128 v[80:83], v16 offset:38912
    v_fma_f32 v96, v120, v18, v6
    v_fma_f32 v97, v121, v18, v6
    v_fma_f32 v98, v122, v18, v6
    v_fma_f32 v99, v123, v18, v6
    v_exp_f32 v96, v96
    v_exp_f32 v97, v97
    v_exp_f32 v98, v98
    v_exp_f32 v99, v99
    s_waitcnt lgkmcnt(3)
    v_mfma_f32_16x16x32_bf16 v[60:63], v[68:71], v[212:215], v[60:63]
    ds_read_b128 v[84:87], v16 offset:39168
    v_fma_f32 v100, v116, -v18, v5
    v_fma_f32 v101, v117, -v18, v5
    v_fma_f32 v102, v118, -v18, v5
    v_fma_f32 v103, v119, -v18, v5
    v_exp_f32 v100, v100
    v_exp_f32 v101, v101
    v_exp_f32 v102, v102
    v_exp_f32 v103, v103
    s_cmp_lt_u32 s9, 28
    s_cbranch_scc0 emd_33
    s_add_u32 m0, s18, 40960
    s_nop 0
    buffer_load_dwordx4 v14, s[60:63], s0 offen lds
    s_cmp_lt_u32 s3, 4
    s_cselect_b32 s60, s26, s28
    s_cselect_b32 s61, s27, s29
    s_mov_b32 s62, 1605632
    s_mov_b32 s63, 0x20000
emd_33:
    s_and_b32 s12, s3, 1
    s_cmp_eq_u32 s12, s7
    s_cbranch_scc0 ewb_34
    v_bfe_u32 v9, v1, 5, 3
    v_lshrrev_b32 v0, 8, v1
    v_xor_b32 v0, v0, v9
    v_and_b32 v9, 0xf0, v1
    v_lshlrev_b32 v9, 3, v9
    v_lshl_add_u32 v0, v0, 4, v9
    s_and_b32 s12, s100, 4
    s_xor_b32 s12, s12, s3
    s_lshr_b32 s12, s12, 1
    s_lshl_b32 s12, s12, 11
    v_add_u32 v0, s12, v0
    v_xor_b32 v9, 64, v0
    ds_write_b128 v0, v[200:203] offset:32768
    ds_write_b128 v9, v[204:207] offset:32768
ewb_34:
    s_waitcnt lgkmcnt(3)
    v_mfma_f32_16x16x32_bf16 v[56:59], v[72:75], v[216:219], v[56:59]
    ds_read_b128 v[64:67], v16 offset:40960
    v_fma_f32 v104, v120, -v18, v7
    v_fma_f32 v105, v121, -v18, v7
    v_fma_f32 v106, v122, -v18, v7
    v_fma_f32 v107, v123, -v18, v7
    v_exp_f32 v104, v104
    v_exp_f32 v105, v105
    v_exp_f32 v106, v106
    v_exp_f32 v107, v107
    s_waitcnt lgkmcnt(3)
    v_mfma_f32_16x16x32_bf16 v[60:63], v[76:79], v[216:219], v[60:63]
    ds_read_b128 v[68:71], v16 offset:41216
    v_add_f32 v4, v92, v93
    v_add_f32 v6, v94, v95
    v_add_f32 v5, v100, v101
    v_add_f32 v7, v102, v103
    v_mul_u32_u24 v9, 56832, v3
    v_bfe_u32 v0, v1, 8, 1
    v_lshl_add_u32 v9, v0, 8, v9
    v_add_u32 v9, v9, v1
    s_lshl_b32 s42, s4, 2
    s_lshr_b32 s13, s3, 2
    s_add_u32 s42, s42, s13
    s_mul_i32 s42, s42, 28
    s_lshl_b32 s13, s6, 2
    s_add_u32 s42, s42, s13
    s_add_u32 s42, s42, s8
    s_lshl_b32 s42, s42, 2
    s_add_u32 s42, s42, s7
    s_lshl_b32 s42, s42, 8
    s_add_u32 s42, s42, 4194304
    s_cmp_eq_u32 s6, 7
    s_cselect_b32 s42, 0x7f000000, s42
    buffer_store_dwordx4 v[124:127], v9, s[44:47], s42 offen sc1
    s_waitcnt lgkmcnt(3)
    v_mfma_f32_16x16x32_bf16 v[56:59], v[80:83], v[220:223], v[56:59]
    ds_read_b128 v[72:75], v16 offset:43008
    v_add_f32 v4, v4, v96
    v_add_f32 v6, v6, v97
    v_add_f32 v5, v5, v104
    v_add_f32 v7, v7, v105
    s_waitcnt lgkmcnt(3)
    v_mfma_f32_16x16x32_bf16 v[60:63], v[84:87], v[220:223], v[60:63]
    ds_read_b128 v[76:79], v16 offset:43264
    v_add_f32 v4, v4, v98
    v_add_f32 v6, v6, v99
    v_add_f32 v5, v5, v106
    v_add_f32 v7, v7, v107
    s_cmp_eq_u32 s3, 0
    s_cbranch_scc0 ew0_35
    v_lshrrev_b32 v9, 1, v1
    s_lshl_b32 s12, s4, 4
    s_add_u32 s12, s12, s5
    s_lshl_b32 s12, s12, 9
    s_add_u32 s12, s12, 6029312
    s_cmp_eq_u32 s6, 7
    s_cselect_b32 s12, 0x7f000000, s12
    buffer_store_dwordx2 v[124:125], v9, s[44:47], s12 offen sc1
ew0_35:
    s_waitcnt lgkmcnt(3)
    v_mfma_f32_16x16x32_bf16 v[56:59], v[64:67], v[224:227], v[56:59]
    ds_read_b128 v[80:83], v16 offset:45056
    v_add_f32 v4, v4, v6
    v_add_f32 v5, v5, v7
    s_waitcnt lgkmcnt(3)
    v_mfma_f32_16x16x32_bf16 v[60:63], v[68:71], v[224:227], v[60:63]
    ds_read_b128 v[84:87], v16 offset:45312
    v_permlane32_swap_b32 v4, v5
    v_add_f32 v4, v4, v5
    v_mov_b32 v5, v4
    v_lshrrev_b32 v9, 7, v1
    v_mul_u32_u24 v9, 896, v9
    v_bfe_u32 v0, v1, 4, 3
    v_min_u32 v0, 6, v0
    v_lshl_add_u32 v9, v0, 7, v9
    s_lshl3_add_u32 s12, s100, s3
    s_mul_i32 s12, s12, 1792
    s_mov_b64 exec, 0xffff
    buffer_load_dword v190, v9, s[56:59], s12 offen
    s_mov_b64 exec, -1
    s_waitcnt lgkmcnt(3)
    v_mfma_f32_16x16x32_bf16 v[56:59], v[72:75], v[228:231], v[56:59]
    ds_read_b128 v[64:67], v16 offset:47104
    v_permlane16_swap_b32 v4, v5
    v_add_f32 v4, v4, v5
    v_rcp_f32 v4, v4
    s_waitcnt lgkmcnt(3)
    v_mfma_f32_16x16x32_bf16 v[60:63], v[76:79], v[228:231], v[60:63]
    ds_read_b128 v[68:71], v16 offset:47360
    v_mov_b32 v5, v4
    s_nop 1
    v_permlane32_swap_b32 v4, v5
    s_mul_i32 s12, s100, 11
    s_mul_i32 s13, s8, 3
    s_add_u32 s12, s12, s13
    s_add_u32 s12, s12, 96
    s_mul_i32 s12, s12, 3584
    s_mul_i32 s13, s7, 1792
    s_add_u32 s12, s12, s13
    s_not_b64 exec, s[24:25]
    buffer_load_dword v191, v167, s[60:63], s12 offen
    s_mov_b64 exec, -1
    s_waitcnt lgkmcnt(3)
    v_mfma_f32_16x16x32_bf16 v[56:59], v[80:83], v[232:235], v[56:59]
    ds_read_b128 v[72:75], v16 offset:49152
    v_mul_f32 v92, v92, v4
    v_mul_f32 v93, v93, v4
    v_mul_f32 v94, v94, v4
    v_mul_f32 v95, v95, v4
    v_cvt_pk_bf16_f32 v108, v92, v93
    v_cvt_pk_bf16_f32 v109, v94, v95
    ds_write_b64 v17, v[108:109] offset:0
    s_waitcnt lgkmcnt(4)
    v_mfma_f32_16x16x32_bf16 v[60:63], v[84:87], v[232:235], v[60:63]
    ds_read_b128 v[76:79], v16 offset:49408
    v_mul_f32 v96, v96, v4
    v_mul_f32 v97, v97, v4
    v_mul_f32 v98, v98, v4
    v_mul_f32 v99, v99, v4
    v_cvt_pk_bf16_f32 v110, v96, v97
    v_cvt_pk_bf16_f32 v111, v98, v99
    ds_write_b64 v17, v[110:111] offset:512
    s_waitcnt vmcnt(3)
    s_add_u32 s13, s72, 81920
    v_add_u32 v0, s13, v1
    ds_read_b32 v156, v0
    s_add_u32 s13, s73, 81920
    v_add_u32 v0, s13, v1
    ds_read_b32 v157, v0
    s_add_u32 s13, s74, 81920
    v_add_u32 v0, s13, v1
    ds_read_b32 v158, v0
    s_add_u32 s13, s75, 81920
    v_add_u32 v0, s13, v1
    ds_read_b32 v159, v0
    s_waitcnt lgkmcnt(3)
    v_max3_u32 v197, v168, v170, v156
    s_waitcnt lgkmcnt(1)
    v_max3_u32 v197, v197, v157, v158
    s_waitcnt lgkmcnt(0)
    v_max_u32 v197, v197, v159
    v_cmp_eq_u32 vcc, -1, v197
    s_cbranch_vccz pd_37
pc_36:
    s_cmp_eq_u32 s11, 0
    s_cbranch_scc1 pd_37
    s_sub_u32 s11, s11, 1
    v_max_u32 v197, v168, v170
    v_cmp_eq_u32 vcc, -1, v197
    s_cbranch_vccz ps_38
    s_mul_i32 s12, s5, 73728
    s_add_u32 s12, s12, s18
    s_add_u32 s12, s12, 6356992
    s_cmp_eq_u32 s3, 7
    s_cmov_b32 s12, 0x7f000000
    buffer_load_dwordx4 v[168:171], v1, s[44:47], s12 offen sc1
ps_38:
    v_cmp_eq_u32 vcc, -1, v156
    s_cbranch_vccz ps_39
    s_add_u32 m0, s72, 81920
    s_add_u32 s12, s64, 28672
    buffer_load_dwordx4 v1, s[44:47], s12 offen sc1 lds
ps_39:
    v_cmp_eq_u32 vcc, -1, v157
    s_cbranch_vccz ps_40
    s_add_u32 m0, s73, 81920
    s_add_u32 s12, s65, 28672
    buffer_load_dwordx4 v1, s[44:47], s12 offen sc1 lds
ps_40:
    v_cmp_eq_u32 vcc, -1, v158
    s_cbranch_vccz ps_41
    s_add_u32 m0, s74, 81920
    s_add_u32 s12, s66, 28672
    buffer_load_dwordx4 v1, s[44:47], s12 offen sc1 lds
ps_41:
    v_cmp_eq_u32 vcc, -1, v159
    s_cbranch_vccz ps_42
    s_add_u32 m0, s75, 81920
    s_add_u32 s12, s67, 28672
    buffer_load_dwordx4 v1, s[44:47], s12 offen sc1 lds
ps_42:
    s_waitcnt vmcnt(0)
    s_add_u32 s13, s72, 81920
    v_add_u32 v0, s13, v1
    ds_read_b32 v156, v0
    s_add_u32 s13, s73, 81920
    v_add_u32 v0, s13, v1
    ds_read_b32 v157, v0
    s_add_u32 s13, s74, 81920
    v_add_u32 v0, s13, v1
    ds_read_b32 v158, v0
    s_add_u32 s13, s75, 81920
    v_add_u32 v0, s13, v1
    ds_read_b32 v159, v0
    s_waitcnt lgkmcnt(3)
    v_max3_u32 v197, v168, v170, v156
    s_waitcnt lgkmcnt(1)
    v_max3_u32 v197, v197, v157, v158
    s_waitcnt lgkmcnt(0)
    v_max_u32 v197, v197, v159
    v_cmp_eq_u32 vcc, -1, v197
    s_waitcnt lgkmcnt(0)
    s_cbranch_vccnz pc_36
    s_nop 4
pd_37:
    v_permlane32_swap_b32 v168, v170
    v_permlane32_swap_b32 v169, v171
    v_and_b32 v0, 0xf0, v1
    v_lshrrev_b32 v197, 8, v1
    v_add_f32 v168, v168, v170
    v_add_f32 v169, v169, v171
    v_lshl_add_u32 v0, v197, 2, v0
    s_lshl_b32 s13, s3, 8
    v_permlane16_swap_b32 v168, v169
    v_add_u32 v0, s13, v0
    v_add_f32 v168, v168, v169
    ds_write_b32 v0, v168 offset:3136
    v_mfma_f32_16x16x32_bf16 v[56:59], v[64:67], v[236:239], v[56:59]
    ds_read_b128 v[80:83], v16 offset:51200
    v_mul_f32 v100, v100, v5
    v_mul_f32 v101, v101, v5
    v_mul_f32 v102, v102, v5
    v_mul_f32 v103, v103, v5
    v_cvt_pk_bf16_f32 v112, v100, v101
    v_cvt_pk_bf16_f32 v113, v102, v103
    ds_write_b64 v17, v[112:113] offset:1024
    v_mfma_f32_16x16x32_bf16 v[60:63], v[68:71], v[236:239], v[60:63]
    ds_read_b128 v[84:87], v16 offset:51456
    v_mul_f32 v104, v104, v5
    v_mul_f32 v105, v105, v5
    v_mul_f32 v106, v106, v5
    v_mul_f32 v107, v107, v5
    v_cvt_pk_bf16_f32 v114, v104, v105
    v_cvt_pk_bf16_f32 v115, v106, v107
    ds_write_b64 v17, v[114:115] offset:1536
    v_mfma_f32_16x16x32_bf16 v[56:59], v[72:75], v[240:243], v[56:59]
    ds_read_b128 v[64:67], v16 offset:53248
    v_mfma_f32_16x16x32_bf16 v[60:63], v[76:79], v[240:243], v[60:63]
    ds_read_b128 v[68:71], v16 offset:53504
    s_waitcnt lgkmcnt(5)
    v_mfma_f32_16x16x32_bf16 v[56:59], v[80:83], v[244:247], v[56:59]
    ds_read_b128 v[72:75], v16 offset:55296
    s_waitcnt lgkmcnt(4)
    v_mfma_f32_16x16x32_bf16 v[60:63], v[84:87], v[244:247], v[60:63]
    ds_read_b128 v[76:79], v16 offset:55552
    s_waitcnt lgkmcnt(3)
    v_mfma_f32_16x16x32_bf16 v[56:59], v[64:67], v[248:251], v[56:59]
    s_waitcnt lgkmcnt(2)
    v_mfma_f32_16x16x32_bf16 v[60:63], v[68:71], v[248:251], v[60:63]
    s_waitcnt lgkmcnt(1)
    v_mfma_f32_16x16x32_bf16 v[56:59], v[72:75], v[252:255], v[56:59]
    s_waitcnt lgkmcnt(0)
    v_mfma_f32_16x16x32_bf16 v[60:63], v[76:79], v[252:255], v[60:63]
    v_mfma_f32_16x16x32_bf16 v[56:59], v[40:43], v[20:23], v[56:59]
    v_mfma_f32_16x16x32_bf16 v[60:63], v[40:43], v[24:27], v[60:63]
    v_subrev_u32 v0, s18, v17
    s_nop 5
    v_mul_f32 v56, v56, v19
    v_mul_f32 v57, v57, v19
    v_mul_f32 v58, v58, v19
    v_mul_f32 v59, v59, v19
    v_mul_f32 v60, v60, v19
    v_mul_f32 v61, v61, v19
    v_mul_f32 v62, v62, v19
    v_mul_f32 v63, v63, v19
    v_cndmask_b32_e64 v60, v60, 1.0, s[24:25]
    v_cvt_pk_bf16_f32 v56, v56, v57
    v_cvt_pk_bf16_f32 v57, v58, v59
    ds_write_b64 v0, v[56:57] offset:16384
    v_cvt_pk_bf16_f32 v58, v60, v61
    v_cvt_pk_bf16_f32 v59, v62, v63
    ds_write_b64 v0, v[58:59] offset:16896
    s_cmp_eq_u32 s3, 4
    s_cbranch_scc0 ew4_43
    v_mov_b32 v0, s10
    s_waitcnt vmcnt(3)
pc_44:
    v_xor_b32 v9, v164, v0
    v_cmp_ne_u32 vcc, 0, v9
    s_cbranch_vccz pd_45
    s_cmp_eq_u32 s11, 0
    s_cbranch_scc1 pd_45
    s_sub_u32 s11, s11, 1
    v_bfe_u32 v165, v1, 4, 4
    v_lshl_add_u32 v164, v165, 4, s4
    s_lshl_b32 s12, s5, 4
    v_add_u32 v165, s12, v165
    v_cndmask_b32_e64 v165, v165, v164, s[76:77]
    v_lshlrev_b32 v165, 7, v165
    v_add_u32 v165, 131072, v165
    buffer_load_dword v164, v165, s[44:47], 0 offen sc1
    s_waitcnt vmcnt(0)
    s_branch pc_44
pd_45:
ew4_43:
    s_waitcnt vmcnt(3)
    s_waitcnt lgkmcnt(0)
    s_barrier
    ds_read_b64_tr_b16 v[144:145], v192 offset:8192
    ds_read_b64_tr_b16 v[64:65], v193 offset:24576
    ds_read_b64_tr_b16 v[146:147], v192 offset:10240
    ds_read_b64_tr_b16 v[66:67], v193 offset:25600
    ds_read_b64_tr_b16 v[148:149], v192 offset:12288
    ds_read_b64_tr_b16 v[68:69], v193 offset:26624
    ds_read_b64_tr_b16 v[150:151], v192 offset:14336
    ds_read_b64_tr_b16 v[70:71], v193 offset:27648
    ds_read_b64_tr_b16 v[152:153], v192 offset:16384
    ds_read_b64_tr_b16 v[72:73], v193 offset:28672
    ds_read_b64_tr_b16 v[154:155], v192 offset:18432
    ds_read_b64_tr_b16 v[74:75], v193 offset:29696
    ds_read_b64_tr_b16 v[156:157], v192 offset:20480
    ds_read_b64_tr_b16 v[76:77], v193 offset:30720
    ds_read_b64_tr_b16 v[158:159], v192 offset:22528
    ds_read_b64_tr_b16 v[78:79], v193 offset:31744
    s_waitcnt lgkmcnt(12)
    v_mfma_f32_16x16x32_bf16 v[80:83], v[144:147], v[64:67], 0
    s_waitcnt lgkmcnt(8)
    v_mfma_f32_16x16x32_bf16 v[80:83], v[148:151], v[68:71], v[80:83]
    s_waitcnt lgkmcnt(4)
    v_mfma_f32_16x16x32_bf16 v[80:83], v[152:155], v[72:75], v[80:83]
    s_waitcnt lgkmcnt(0)
    v_mfma_f32_16x16x32_bf16 v[80:83], v[156:159], v[76:79], v[80:83]
    s_nop 7
    v_cvt_pk_bf16_f32 v80, v80, v81
    v_cvt_pk_bf16_f32 v81, v82, v83
    buffer_store_dwordx2 v[80:81], v195, s[44:47], s23 offen sc1
    ds_read_b64 v[108:109], v194 offset:32768
    ds_read_b64 v[110:111], v194 offset:36864
    s_cmp_lt_u32 s9, 28
    s_cbranch_scc0 emd_46
    v_bfe_u32 v8, v1, 6, 2
    v_bfe_u32 v0, v1, 8, 1
    v_lshl_add_u32 v9, v0, 2, v8
    v_lshl_add_u32 v9, v3, 4, v9
    v_bfe_u32 v8, v9, 1, 2
    v_xor_b32 v8, s8, v8
    v_lshlrev_b32 v9, 7, v9
    v_lshl_add_u32 v9, v8, 5, v9
    v_bfe_u32 v8, v1, 4, 2
    v_lshl_add_u32 v9, v8, 3, v9
    s_cmp_lt_u32 s3, 4
    s_mov_b32 s12, 139264
    s_cmov_b32 s12, 110592
    s_mov_b32 s13, 20480
    s_cmov_b32 s13, 110592
    v_add_u32 v8, s12, v9
    v_add_u32 v9, s13, v9
    s_mov_b32 s12, 163264
    s_cmov_b32 s12, 162816
    v_lshrrev_b32 v0, 8, v1
    v_lshl_add_u32 v0, v0, 4, s12
    ds_read_b64_tr_b16 v[144:145], v8 offset:0
    ds_read_b64_tr_b16 v[146:147], v8 offset:1024
    ds_read_b128 v[128:131], v0 offset:0
    ds_read_b64_tr_b16 v[148:149], v8 offset:4096
    ds_read_b64_tr_b16 v[150:151], v8 offset:5120
    ds_read_b128 v[132:135], v0 offset:64
    ds_read_b64_tr_b16 v[152:153], v8 offset:8192
    ds_read_b64_tr_b16 v[154:155], v8 offset:9216
    ds_read_b128 v[136:139], v0 offset:128
    ds_read_b64_tr_b16 v[156:157], v8 offset:12288
    ds_read_b64_tr_b16 v[158:159], v8 offset:13312
    ds_read_b128 v[140:143], v0 offset:192
    ds_read_b64_tr_b16 v[160:161], v8 offset:16384
    ds_read_b64_tr_b16 v[162:163], v8 offset:17408
    ds_read_b128 v[172:175], v0 offset:256
    ds_read_b64_tr_b16 v[164:165], v9 offset:20480
    ds_read_b64_tr_b16 v[166:167], v9 offset:21504
    ds_read_b128 v[176:179], v0 offset:320
    ds_read_b64_tr_b16 v[168:169], v9 offset:24576
    ds_read_b64_tr_b16 v[170:171], v9 offset:25600
    ds_read_b128 v[180:183], v0 offset:384
    s_lshl_b32 s12, s3, 8
    s_add_u32 s12, s12, 159744
    s_waitcnt lgkmcnt(15)
    v_mfma_f32_16x16x32_bf16 v[184:187], v[128:131], v[144:147], 0
    v_mfma_f32_16x16x32_bf16 v[184:187], v[132:135], v[148:151], v[184:187]
    s_waitcnt lgkmcnt(12)
    v_mfma_f32_16x16x32_bf16 v[184:187], v[136:139], v[152:155], v[184:187]
    s_waitcnt lgkmcnt(9)
    v_mfma_f32_16x16x32_bf16 v[184:187], v[140:143], v[156:159], v[184:187]
    s_waitcnt lgkmcnt(6)
    v_mfma_f32_16x16x32_bf16 v[184:187], v[172:175], v[160:163], v[184:187]
    s_waitcnt lgkmcnt(3)
    v_mfma_f32_16x16x32_bf16 v[184:187], v[176:179], v[164:167], v[184:187]
    s_waitcnt lgkmcnt(0)
    v_mfma_f32_16x16x32_bf16 v[184:187], v[180:183], v[168:171], v[184:187]
    v_lshrrev_b32 v8, 2, v1
    v_add_u32 v8, s12, v8
    s_nop 5
    ds_write_b32 v8, v184
emd_46:
    s_cmp_lg_u32 s6, 7
    s_cbranch_scc0 en7_47
    ds_read_b64_tr_b16 v[144:145], v11 offset:8192
    ds_read_b64_tr_b16 v[146:147], v11 offset:10240
    ds_read_b64_tr_b16 v[148:149], v11 offset:16384
    ds_read_b64_tr_b16 v[150:151], v11 offset:18432
    ds_read_b64_tr_b16 v[152:153], v11 offset:24576
    ds_read_b64_tr_b16 v[154:155], v11 offset:26624
    ds_read_b64_tr_b16 v[156:157], v11 offset:32768
    ds_read_b64_tr_b16 v[158:159], v11 offset:34816
    ds_read_b64_tr_b16 v[160:161], v11 offset:40960
    ds_read_b64_tr_b16 v[162:163], v11 offset:43008
    ds_read_b64_tr_b16 v[164:165], v11 offset:49152
    ds_read_b64_tr_b16 v[166:167], v11 offset:51200
en7_47:
    v_add_u32 v16, 57344, v16
    s_waitcnt lgkmcnt(0)
    s_barrier
    s_cmp_eq_u32 s3, 7
    s_cselect_b32 s12, s9, 99
    s_cmp_lt_u32 s12, 28
    s_cbranch_scc0 emd7_48
    v_lshrrev_b32 v8, 2, v1
    v_and_b32 v9, 0xf0, v1
    v_lshrrev_b32 v9, 2, v9
    v_and_b32 v144, 0x300, v1
    v_add_u32 v9, v9, v144
    v_add_u32 v9, 159744, v9
    ds_read_b32 v144, v9 offset:0
    ds_read_b32 v148, v9 offset:1024
    s_sub_u32 s13, s9, 14
    s_cmp_lt_u32 s13, 7
    s_cselect_b32 s12, 1.0, 0
    s_lshl_b32 s13, s9, 9
    s_add_u32 s13, s13, 72704
    v_lshlrev_b32 v8, 1, v8
    v_mov_b32 v153, s10
    s_waitcnt lgkmcnt(0)
    v_add_f32 v144, v144, v148
    v_cvt_pk_bf16_f32 v144, 0, v144
    v_add_f32 v144, s12, v144
    v_cvt_pk_bf16_f32 v152, 0, v144
    buffer_store_dwordx2 v[152:153], v8, s[44:47], s13 offen sc1
emd7_48:
    s_cmp_eq_u32 s6, 7
    s_cselect_b32 s26, 4, s3
    s_cmp_lt_u32 s26, 4
    s_cbranch_scc0 elo7_49
    ds_read_b128 v[64:67], v16 offset:0
    ds_read_b128 v[68:71], v16 offset:256
    ds_read_b128 v[72:75], v16 offset:2048
    ds_read_b128 v[76:79], v16 offset:2304
    ds_read_b128 v[80:83], v16 offset:4096
    v_lshlrev_b32 v0, 3, v2
    v_add_u32 v0, 3136, v0
    ds_read2_b64 v[92:95], v0 offset0:0 offset1:32
    ds_read2_b64 v[96:99], v0 offset0:64 offset1:96
    ds_read2_b64 v[100:103], v0 offset0:128 offset1:160
    ds_read2_b64 v[104:107], v0 offset0:192 offset1:224
    s_mul_i32 s15, s8, 7168
    s_add_u32 m0, s15, 49152
    s_nop 0
    buffer_load_dwordx4 v13, s[56:59], s17 offen lds
    s_waitcnt lgkmcnt(8)
    v_mfma_f32_16x16x32_bf16 v[48:51], v[64:67], v[200:203], 0
    s_waitcnt lgkmcnt(7)
    v_mfma_f32_16x16x32_bf16 v[52:55], v[68:71], v[200:203], 0
    ds_read_b128 v[84:87], v16 offset:4352
    s_waitcnt lgkmcnt(4)
    v_pk_add_f32 v[92:93], v[92:93], v[94:95]
    s_waitcnt lgkmcnt(3)
    v_pk_add_f32 v[96:97], v[96:97], v[98:99]
    s_waitcnt lgkmcnt(2)
    v_pk_add_f32 v[100:101], v[100:101], v[102:103]
    s_waitcnt lgkmcnt(1)
    v_pk_add_f32 v[104:105], v[104:105], v[106:107]
    s_add_u32 m0, s15, 50176
    s_add_u32 s17, s17, 7168
    buffer_load_dwordx4 v13, s[56:59], s17 offen lds
    v_mfma_f32_16x16x32_bf16 v[48:51], v[72:75], v[204:207], v[48:51]
    ds_read_b128 v[64:67], v16 offset:6144
    v_pk_add_f32 v[92:93], v[92:93], v[96:97]
    v_pk_add_f32 v[100:101], v[100:101], v[104:105]
    v_pk_add_f32 v[92:93], v[92:93], v[100:101]
    v_mfma_f32_16x16x32_bf16 v[52:55], v[76:79], v[204:207], v[52:55]
    ds_read_b128 v[68:71], v16 offset:6400
    v_cvt_pk_bf16_f32 v41, v93, v92
    v_lshlrev_b32 v94, 16, v41
    v_and_b32 v95, 0xffff0000, v41
    v_sub_f32 v93, v93, v94
    s_add_u32 m0, s15, 51200
    s_add_u32 s17, s17, 7168
    buffer_load_dwordx4 v13, s[56:59], s17 offen lds
    v_mfma_f32_16x16x32_bf16 v[48:51], v[80:83], v[208:211], v[48:51]
    ds_read_b128 v[72:75], v16 offset:8192
    v_sub_f32 v92, v92, v95
    v_cvt_pk_bf16_f32 v92, v93, v92
    v_perm_b32 v40, v92, v41, s38
    v_perm_b32 v42, v41, v92, s39
    s_waitcnt lgkmcnt(3)
    v_mfma_f32_16x16x32_bf16 v[52:55], v[84:87], v[208:211], v[52:55]
    ds_read_b128 v[76:79], v16 offset:8448
    v_bfe_u32 v132, v1, 5, 3
    v_bfe_u32 v133, v1, 8, 1
    v_lshlrev_b32 v133, 2, v133
    v_xor_b32 v132, v132, v133
    s_add_u32 m0, s15, 52224
    s_add_u32 s17, s17, 7168
    buffer_load_dwordx4 v13, s[56:59], s17 offen lds
    s_waitcnt lgkmcnt(3)
    v_mfma_f32_16x16x32_bf16 v[48:51], v[64:67], v[212:215], v[48:51]
    ds_read_b128 v[80:83], v16 offset:10240
    v_and_b32 v134, 16, v1
    v_mov_b32 v135, 0x3f80
    v_lshlrev_b32 v134, v134, v135
    s_waitcnt lgkmcnt(3)
    v_mfma_f32_16x16x32_bf16 v[52:55], v[68:71], v[212:215], v[52:55]
    ds_read_b128 v[84:87], v16 offset:10496
    v_cmp_eq_u32 vcc, 0, v132
    s_nop 1
    v_cndmask_b32 v128, 0, v134, vcc
    v_cmp_eq_u32 vcc, 1, v132
    s_nop 1
    v_cndmask_b32 v129, 0, v134, vcc
    s_add_u32 m0, s15, 53248
    s_add_u32 s17, s17, 7168
    buffer_load_dwordx4 v13, s[56:59], s17 offen lds
    s_waitcnt lgkmcnt(3)
    v_mfma_f32_16x16x32_bf16 v[48:51], v[72:75], v[216:219], v[48:51]
    ds_read_b128 v[64:67], v16 offset:12288
    v_cmp_eq_u32 vcc, 2, v132
    s_nop 1
    v_cndmask_b32 v130, 0, v134, vcc
    v_cmp_eq_u32 vcc, 3, v132
    s_nop 1
    v_cndmask_b32 v131, 0, v134, vcc
    s_waitcnt lgkmcnt(3)
    v_mfma_f32_16x16x32_bf16 v[52:55], v[76:79], v[216:219], v[52:55]
    ds_read_b128 v[68:71], v16 offset:12544
    s_lshr_b32 s12, s3, 2
    s_mul_i32 s12, s12, 6144
    s_and_b32 s13, s3, 2
    s_lshl_b32 s13, s13, 9
    s_add_u32 s12, s12, s13
    s_and_b32 s13, s3, 1
    s_lshl3_add_u32 s12, s13, s12
    v_add_u32 v45, s12, v1
    s_add_u32 m0, s15, 54272
    s_add_u32 s17, s17, 7168
    buffer_load_dwordx4 v13, s[56:59], s17 offen lds
    s_waitcnt lgkmcnt(3)
    v_mfma_f32_16x16x32_bf16 v[48:51], v[80:83], v[220:223], v[48:51]
    ds_read_b128 v[72:75], v16 offset:14336
    s_min_u32 s13, s3, 6
    s_lshl_b32 s13, s13, 7
    v_lshrrev_b32 v132, 3, v1
    v_add_u32 v132, s13, v132
    v_cmp_gt_u32 vcc, 448, v132
    v_subrev_u32 v133, 448, v132
    s_nop 0
    v_cndmask_b32 v133, v133, v132, vcc
    v_cndmask_b32_e64 v134, 0, 32, vcc
    s_waitcnt lgkmcnt(3)
    v_mfma_f32_16x16x32_bf16 v[52:55], v[84:87], v[220:223], v[52:55]
    ds_read_b128 v[76:79], v16 offset:14592
    v_lshrrev_b32 v135, 4, v133
    v_sub_u32 v135, 27, v135
    v_mul_u32_u24 v135, 80, v135
    v_add_u32 v134, v134, v135
    s_add_u32 m0, s15, 55296
    s_add_u32 s17, s17, 7168
    buffer_load_dwordx4 v13, s[56:59], s17 offen lds
    s_waitcnt lgkmcnt(3)
    v_mfma_f32_16x16x32_bf16 v[48:51], v[64:67], v[224:227], v[48:51]
    ds_read_b128 v[80:83], v16 offset:16384
    v_bfe_u32 v135, v133, 2, 1
    v_lshl_add_u32 v134, v135, 4, v134
    v_bfe_u32 v135, v133, 3, 1
    v_lshl_add_u32 v134, v135, 3, v134
    s_waitcnt lgkmcnt(3)
    v_mfma_f32_16x16x32_bf16 v[52:55], v[68:71], v[224:227], v[52:55]
    ds_read_b128 v[84:87], v16 offset:16640
    v_and_b32 v135, 2, v133
    v_lshl_add_u32 v44, v135, 1, v134
    v_lshrrev_b32 v132, 2, v1
    v_add_u32 v132, 2304, v132
    s_cmp_eq_u32 s3, 7
    s_cselect_b64 vcc, -1, 0
    v_cndmask_b32 v44, v44, v132, vcc
    s_add_u32 m0, s15, 110592
    s_add_u32 s17, s17, 7168
    buffer_load_dwordx4 v13, s[56:59], s17 offen lds
    s_waitcnt lgkmcnt(3)
    v_mfma_f32_16x16x32_bf16 v[48:51], v[72:75], v[228:231], v[48:51]
    ds_read_b128 v[64:67], v16 offset:18432
    v_bfe_u32 v132, v1, 6, 2
    v_lshrrev_b32 v133, 8, v1
    v_mul_u32_u24 v46, 7168, v133
    v_lshl_add_u32 v46, v132, 7, v46
    s_waitcnt lgkmcnt(3)
    v_mfma_f32_16x16x32_bf16 v[52:55], v[76:79], v[228:231], v[52:55]
    ds_read_b128 v[68:71], v16 offset:18688
    v_lshrrev_b32 v132, 1, v132
    v_and_b32 v133, 1, v133
    v_lshl_add_u32 v132, v133, 1, v132
    v_xor_b32 v132, s8, v132
    s_add_u32 m0, s15, 111616
    s_add_u32 s17, s17, 7168
    buffer_load_dwordx4 v13, s[56:59], s17 offen lds
    s_waitcnt lgkmcnt(3)
    v_mfma_f32_16x16x32_bf16 v[48:51], v[80:83], v[232:235], v[48:51]
    ds_read_b128 v[72:75], v16 offset:20480
    v_lshl_add_u32 v46, v132, 5, v46
    v_bfe_u32 v132, v1, 4, 2
    v_lshl_add_u32 v46, v132, 3, v46
    v_add_u32 v47, 110592, v46
    v_add_u32 v46, 49152, v46
    s_waitcnt lgkmcnt(3)
    v_mfma_f32_16x16x32_bf16 v[52:55], v[84:87], v[232:235], v[52:55]
    ds_read_b128 v[76:79], v16 offset:20736
    s_add_u32 m0, s15, 112640
    s_add_u32 s17, s17, 7168
    buffer_load_dwordx4 v13, s[56:59], s17 offen lds
    s_waitcnt lgkmcnt(3)
    v_mfma_f32_16x16x32_bf16 v[48:51], v[64:67], v[236:239], v[48:51]
    ds_read_b128 v[80:83], v16 offset:22528
    s_waitcnt lgkmcnt(3)
    v_mfma_f32_16x16x32_bf16 v[52:55], v[68:71], v[236:239], v[52:55]
    ds_read_b128 v[84:87], v16 offset:22784
    s_add_u32 m0, s15, 113664
    s_add_u32 s17, s17, 7168
    buffer_load_dwordx4 v13, s[56:59], s17 offen lds
    s_waitcnt lgkmcnt(3)
    v_mfma_f32_16x16x32_bf16 v[48:51], v[72:75], v[240:243], v[48:51]
    ds_read_b128 v[64:67], v16 offset:24576
    s_waitcnt lgkmcnt(3)
    v_mfma_f32_16x16x32_bf16 v[52:55], v[76:79], v[240:243], v[52:55]
    ds_read_b128 v[68:71], v16 offset:24832
    s_add_u32 m0, s15, 114688
    s_add_u32 s17, s17, 7168
    buffer_load_dwordx4 v13, s[56:59], s17 offen lds
    s_waitcnt lgkmcnt(3)
    v_mfma_f32_16x16x32_bf16 v[48:51], v[80:83], v[244:247], v[48:51]
    ds_read_b128 v[72:75], v16 offset:26624
    s_waitcnt lgkmcnt(3)
    v_mfma_f32_16x16x32_bf16 v[52:55], v[84:87], v[244:247], v[52:55]
    ds_read_b128 v[76:79], v16 offset:26880
    s_add_u32 m0, s15, 115712
    s_add_u32 s17, s17, 7168
    buffer_load_dwordx4 v13, s[56:59], s17 offen lds
    s_waitcnt lgkmcnt(3)
    v_mfma_f32_16x16x32_bf16 v[48:51], v[64:67], v[248:251], v[48:51]
    s_waitcnt lgkmcnt(2)
    v_mfma_f32_16x16x32_bf16 v[52:55], v[68:71], v[248:251], v[52:55]
    s_add_u32 m0, s15, 116736
    s_add_u32 s17, s17, 7168
    buffer_load_dwordx4 v13, s[56:59], s17 offen lds
    s_waitcnt lgkmcnt(1)
    v_mfma_f32_16x16x32_bf16 v[48:51], v[72:75], v[252:255], v[48:51]
    s_waitcnt lgkmcnt(0)
    v_mfma_f32_16x16x32_bf16 v[52:55], v[76:79], v[252:255], v[52:55]
    v_mfma_f32_16x16x32_bf16 v[48:51], v[40:43], v[20:23], v[48:51]
    v_mfma_f32_16x16x32_bf16 v[52:55], v[40:43], v[24:27], v[52:55]
elo7_49:
    s_cmp_ge_u32 s26, 4
    s_cbranch_scc0 ehi7_50
    ds_read_b128 v[64:67], v16 offset:0
    ds_read_b128 v[68:71], v16 offset:256
    ds_read_b128 v[72:75], v16 offset:2048
    ds_read_b128 v[76:79], v16 offset:2304
    ds_read_b128 v[80:83], v16 offset:4096
    v_lshlrev_b32 v0, 3, v2
    v_add_u32 v0, 3136, v0
    ds_read2_b64 v[92:95], v0 offset0:0 offset1:32
    ds_read2_b64 v[96:99], v0 offset0:64 offset1:96
    ds_read2_b64 v[100:103], v0 offset0:128 offset1:160
    ds_read2_b64 v[104:107], v0 offset0:192 offset1:224
    s_waitcnt lgkmcnt(8)
    v_mfma_f32_16x16x32_bf16 v[48:51], v[64:67], v[200:203], 0
    s_waitcnt lgkmcnt(7)
    v_mfma_f32_16x16x32_bf16 v[52:55], v[68:71], v[200:203], 0
    ds_read_b128 v[84:87], v16 offset:4352
    s_waitcnt lgkmcnt(4)
    v_pk_add_f32 v[92:93], v[92:93], v[94:95]
    s_waitcnt lgkmcnt(3)
    v_pk_add_f32 v[96:97], v[96:97], v[98:99]
    s_waitcnt lgkmcnt(2)
    v_pk_add_f32 v[100:101], v[100:101], v[102:103]
    s_waitcnt lgkmcnt(1)
    v_pk_add_f32 v[104:105], v[104:105], v[106:107]
    v_mfma_f32_16x16x32_bf16 v[48:51], v[72:75], v[204:207], v[48:51]
    ds_read_b128 v[64:67], v16 offset:6144
    v_pk_add_f32 v[92:93], v[92:93], v[96:97]
    v_pk_add_f32 v[100:101], v[100:101], v[104:105]
    v_pk_add_f32 v[92:93], v[92:93], v[100:101]
    v_mfma_f32_16x16x32_bf16 v[52:55], v[76:79], v[204:207], v[52:55]
    ds_read_b128 v[68:71], v16 offset:6400
    v_cvt_pk_bf16_f32 v41, v93, v92
    v_lshlrev_b32 v94, 16, v41
    v_and_b32 v95, 0xffff0000, v41
    v_sub_f32 v93, v93, v94
    v_mfma_f32_16x16x32_bf16 v[48:51], v[80:83], v[208:211], v[48:51]
    ds_read_b128 v[72:75], v16 offset:8192
    v_sub_f32 v92, v92, v95
    v_cvt_pk_bf16_f32 v92, v93, v92
    v_perm_b32 v40, v92, v41, s38
    v_perm_b32 v42, v41, v92, s39
    s_waitcnt lgkmcnt(3)
    v_mfma_f32_16x16x32_bf16 v[52:55], v[84:87], v[208:211], v[52:55]
    ds_read_b128 v[76:79], v16 offset:8448
    v_bfe_u32 v132, v1, 5, 3
    v_bfe_u32 v133, v1, 8, 1
    v_lshlrev_b32 v133, 2, v133
    v_xor_b32 v132, v132, v133
    s_waitcnt lgkmcnt(3)
    v_mfma_f32_16x16x32_bf16 v[48:51], v[64:67], v[212:215], v[48:51]
    ds_read_b128 v[80:83], v16 offset:10240
    v_and_b32 v134, 16, v1
    v_mov_b32 v135, 0x3f80
    v_lshlrev_b32 v134, v134, v135
    s_waitcnt lgkmcnt(3)
    v_mfma_f32_16x16x32_bf16 v[52:55], v[68:71], v[212:215], v[52:55]
    ds_read_b128 v[84:87], v16 offset:10496
    v_cmp_eq_u32 vcc, 0, v132
    s_nop 1
    v_cndmask_b32 v128, 0, v134, vcc
    v_cmp_eq_u32 vcc, 1, v132
    s_nop 1
    v_cndmask_b32 v129, 0, v134, vcc
    s_waitcnt lgkmcnt(3)
    v_mfma_f32_16x16x32_bf16 v[48:51], v[72:75], v[216:219], v[48:51]
    ds_read_b128 v[64:67], v16 offset:12288
    v_cmp_eq_u32 vcc, 2, v132
    s_nop 1
    v_cndmask_b32 v130, 0, v134, vcc
    v_cmp_eq_u32 vcc, 3, v132
    s_nop 1
    v_cndmask_b32 v131, 0, v134, vcc
    s_waitcnt lgkmcnt(3)
    v_mfma_f32_16x16x32_bf16 v[52:55], v[76:79], v[216:219], v[52:55]
    ds_read_b128 v[68:71], v16 offset:12544
    s_lshr_b32 s12, s3, 2
    s_mul_i32 s12, s12, 6144
    s_and_b32 s13, s3, 2
    s_lshl_b32 s13, s13, 9
    s_add_u32 s12, s12, s13
    s_and_b32 s13, s3, 1
    s_lshl3_add_u32 s12, s13, s12
    v_add_u32 v45, s12, v1
    s_add_u32 m0, s18, 8192
    s_add_u32 s12, s16, 344064
    buffer_load_dwordx4 v14, s[60:63], s12 offen lds
    s_waitcnt lgkmcnt(3)
    v_mfma_f32_16x16x32_bf16 v[48:51], v[80:83], v[220:223], v[48:51]
    ds_read_b128 v[72:75], v16 offset:14336
    s_min_u32 s13, s3, 6
    s_lshl_b32 s13, s13, 7
    v_lshrrev_b32 v132, 3, v1
    v_add_u32 v132, s13, v132
    v_cmp_gt_u32 vcc, 448, v132
    v_subrev_u32 v133, 448, v132
    s_nop 0
    v_cndmask_b32 v133, v133, v132, vcc
    v_cndmask_b32_e64 v134, 0, 32, vcc
    s_waitcnt lgkmcnt(3)
    v_mfma_f32_16x16x32_bf16 v[52:55], v[84:87], v[220:223], v[52:55]
    ds_read_b128 v[76:79], v16 offset:14592
    v_lshrrev_b32 v135, 4, v133
    v_sub_u32 v135, 27, v135
    v_mul_u32_u24 v135, 80, v135
    v_add_u32 v134, v134, v135
    s_waitcnt lgkmcnt(3)
    v_mfma_f32_16x16x32_bf16 v[48:51], v[64:67], v[224:227], v[48:51]
    ds_read_b128 v[80:83], v16 offset:16384
    v_bfe_u32 v135, v133, 2, 1
    v_lshl_add_u32 v134, v135, 4, v134
    v_bfe_u32 v135, v133, 3, 1
    v_lshl_add_u32 v134, v135, 3, v134
    s_add_u32 m0, s18, 16384
    s_add_u32 s12, s16, 401408
    buffer_load_dwordx4 v14, s[60:63], s12 offen lds
    s_waitcnt lgkmcnt(3)
    v_mfma_f32_16x16x32_bf16 v[52:55], v[68:71], v[224:227], v[52:55]
    ds_read_b128 v[84:87], v16 offset:16640
    v_and_b32 v135, 2, v133
    v_lshl_add_u32 v44, v135, 1, v134
    v_lshrrev_b32 v132, 2, v1
    v_add_u32 v132, 2304, v132
    s_cmp_eq_u32 s3, 7
    s_cselect_b64 vcc, -1, 0
    v_cndmask_b32 v44, v44, v132, vcc
    s_waitcnt lgkmcnt(3)
    v_mfma_f32_16x16x32_bf16 v[48:51], v[72:75], v[228:231], v[48:51]
    ds_read_b128 v[64:67], v16 offset:18432
    v_bfe_u32 v132, v1, 6, 2
    v_lshrrev_b32 v133, 8, v1
    v_mul_u32_u24 v46, 7168, v133
    v_lshl_add_u32 v46, v132, 7, v46
    s_waitcnt lgkmcnt(3)
    v_mfma_f32_16x16x32_bf16 v[52:55], v[76:79], v[228:231], v[52:55]
    ds_read_b128 v[68:71], v16 offset:18688
    v_lshrrev_b32 v132, 1, v132
    v_and_b32 v133, 1, v133
    v_lshl_add_u32 v132, v133, 1, v132
    v_xor_b32 v132, s8, v132
    s_add_u32 m0, s18, 24576
    s_add_u32 s12, s16, 458752
    buffer_load_dwordx4 v14, s[60:63], s12 offen lds
    s_waitcnt lgkmcnt(3)
    v_mfma_f32_16x16x32_bf16 v[48:51], v[80:83], v[232:235], v[48:51]
    ds_read_b128 v[72:75], v16 offset:20480
    v_lshl_add_u32 v46, v132, 5, v46
    v_bfe_u32 v132, v1, 4, 2
    v_lshl_add_u32 v46, v132, 3, v46
    v_add_u32 v47, 110592, v46
    v_add_u32 v46, 49152, v46
    s_waitcnt lgkmcnt(3)
    v_mfma_f32_16x16x32_bf16 v[52:55], v[84:87], v[232:235], v[52:55]
    ds_read_b128 v[76:79], v16 offset:20736
    s_waitcnt lgkmcnt(3)
    v_mfma_f32_16x16x32_bf16 v[48:51], v[64:67], v[236:239], v[48:51]
    ds_read_b128 v[80:83], v16 offset:22528
    s_add_u32 m0, s18, 32768
    s_add_u32 s12, s16, 516096
    buffer_load_dwordx4 v14, s[60:63], s12 offen lds
    s_waitcnt lgkmcnt(3)
    v_mfma_f32_16x16x32_bf16 v[52:55], v[68:71], v[236:239], v[52:55]
    ds_read_b128 v[84:87], v16 offset:22784
    s_waitcnt lgkmcnt(3)
    v_mfma_f32_16x16x32_bf16 v[48:51], v[72:75], v[240:243], v[48:51]
    ds_read_b128 v[64:67], v16 offset:24576
    s_waitcnt lgkmcnt(3)
    v_mfma_f32_16x16x32_bf16 v[52:55], v[76:79], v[240:243], v[52:55]
    ds_read_b128 v[68:71], v16 offset:24832
    s_add_u32 m0, s18, 40960
    s_add_u32 s12, s16, 573440
    buffer_load_dwordx4 v14, s[60:63], s12 offen lds
    s_waitcnt lgkmcnt(3)
    v_mfma_f32_16x16x32_bf16 v[48:51], v[80:83], v[244:247], v[48:51]
    ds_read_b128 v[72:75], v16 offset:26624
    s_waitcnt lgkmcnt(3)
    v_mfma_f32_16x16x32_bf16 v[52:55], v[84:87], v[244:247], v[52:55]
    ds_read_b128 v[76:79], v16 offset:26880
    s_waitcnt lgkmcnt(3)
    v_mfma_f32_16x16x32_bf16 v[48:51], v[64:67], v[248:251], v[48:51]
    s_add_u32 m0, s18, 139264
    s_add_u32 s12, s16, 630784
    buffer_load_dwordx4 v14, s[60:63], s12 offen lds
    s_waitcnt lgkmcnt(2)
    v_mfma_f32_16x16x32_bf16 v[52:55], v[68:71], v[248:251], v[52:55]
    s_waitcnt lgkmcnt(1)
    v_mfma_f32_16x16x32_bf16 v[48:51], v[72:75], v[252:255], v[48:51]
    s_waitcnt lgkmcnt(0)
    v_mfma_f32_16x16x32_bf16 v[52:55], v[76:79], v[252:255], v[52:55]
    v_mfma_f32_16x16x32_bf16 v[48:51], v[40:43], v[20:23], v[48:51]
    v_mfma_f32_16x16x32_bf16 v[52:55], v[40:43], v[24:27], v[52:55]
ehi7_50:
    s_add_u32 s14, s20, 4096
    s_nop 6
    v_cvt_pk_bf16_f32 v48, v48, v49
    v_cvt_pk_bf16_f32 v49, v50, v51
    v_cvt_pk_bf16_f32 v50, v52, v53
    v_cvt_pk_bf16_f32 v51, v54, v55
    s_nop 1
    v_mfma_f32_16x16x32_bf16 v[116:119], v[32:35], v[48:51], 0
    v_mfma_f32_16x16x32_bf16 v[120:123], v[36:39], v[48:51], 0
    v_mov_b32 v48, v108
    v_mov_b32 v49, v109
    v_mov_b32 v50, v110
    v_mov_b32 v51, v111
    s_nop 2
    v_max3_f32 v4, v116, v117, v118
    v_min3_f32 v5, v116, v117, v118
    v_max3_f32 v6, v120, v121, v122
    v_min3_f32 v7, v120, v121, v122
    buffer_load_dwordx4 v[168:171], v1, s[44:47], s20 offen offset:0 sc1
    buffer_load_dwordx4 v[172:175], v1, s[44:47], s20 offen offset:1024 sc1
    buffer_load_dwordx4 v[176:179], v1, s[44:47], s20 offen offset:2048 sc1
    buffer_load_dwordx4 v[180:183], v1, s[44:47], s20 offen offset:3072 sc1
    buffer_load_dwordx4 v[184:187], v1, s[44:47], s14 offen offset:0 sc1
    s_waitcnt vmcnt(6)
    buffer_load_dwordx4 v[188:191], v1, s[44:47], s14 offen offset:1024 sc1
    buffer_load_dwordx4 v[192:195], v1, s[44:47], s14 offen offset:2048 sc1
    buffer_load_dwordx4 v[196:199], v1, s[44:47], s14 offen offset:3072 sc1
    v_max_f32 v4, v4, v119
    v_min_f32 v5, v5, v119
    v_max3_f32 v6, v6, v123, v4
    v_min3_f32 v7, v7, v123, v5
    s_add_u32 s15, s18, 76288
    s_lshl_b32 s13, s6, 9
    s_add_u32 s13, s13, 72704
    s_cmp_eq_u32 s3, 7
    s_cselect_b32 s15, s13, s15
    s_cselect_b32 s13, 10240, 0
    v_mad_u32_u24 v12, v3, s13, v1
    buffer_load_dwordx4 v[28:31], v12, s[44:47], s15 offen sc1
    v_cndmask_b32_e64 v4, v6, v4, s[24:25]
    v_cndmask_b32_e64 v5, -v7, -v5, s[24:25]
    s_nop 1
    v_permlane32_swap_b32 v4, v5
    v_max_f32 v4, v4, v5
    v_mov_b32 v5, v4
    s_nop 1
    v_permlane16_swap_b32 v4, v5
    v_max_f32 v4, v4, v5
    v_mul_f32_e64 v4, v4, -v18
    v_mov_b32 v5, v4
    s_nop 1
    v_permlane32_swap_b32 v4, v5
    v_mov_b32 v8, 0xff800000
    v_cndmask_b32_e64 v6, v4, v8, s[24:25]
    v_cndmask_b32_e64 v7, v5, v8, s[24:25]
    v_fma_f32 v92, v116, v18, v4
    v_fma_f32 v93, v117, v18, v4
    v_fma_f32 v94, v118, v18, v4
    v_fma_f32 v95, v119, v18, v4
    v_exp_f32 v92, v92
    v_exp_f32 v93, v93
    v_exp_f32 v94, v94
    v_exp_f32 v95, v95
    v_fma_f32 v96, v120, v18, v6
    v_fma_f32 v97, v121, v18, v6
    v_fma_f32 v98, v122, v18, v6
    v_fma_f32 v99, v123, v18, v6
    v_exp_f32 v96, v96
    v_exp_f32 v97, v97
    v_exp_f32 v98, v98
    v_exp_f32 v99, v99
    v_fma_f32 v100, v116, -v18, v5
    v_fma_f32 v101, v117, -v18, v5
    v_fma_f32 v102, v118, -v18, v5
    v_fma_f32 v103, v119, -v18, v5
    v_exp_f32 v100, v100
    v_exp_f32 v101, v101
    v_exp_f32 v102, v102
    v_exp_f32 v103, v103
    v_fma_f32 v104, v120, -v18, v7
    v_fma_f32 v105, v121, -v18, v7
    v_fma_f32 v106, v122, -v18, v7
    v_fma_f32 v107, v123, -v18, v7
    v_exp_f32 v104, v104
    v_exp_f32 v105, v105
    v_exp_f32 v106, v106
    v_exp_f32 v107, v107
    v_add_f32 v4, v92, v93
    v_add_f32 v6, v94, v95
    v_add_f32 v5, v100, v101
    v_add_f32 v7, v102, v103
    v_add_f32 v4, v4, v96
    v_add_f32 v6, v6, v97
    v_add_f32 v5, v5, v104
    v_add_f32 v7, v7, v105
    v_add_f32 v4, v4, v98
    v_add_f32 v6, v6, v99
    v_add_f32 v5, v5, v106
    v_add_f32 v7, v7, v107
    v_add_f32 v4, v4, v6
    v_add_f32 v5, v5, v7
    s_nop 1
    v_permlane32_swap_b32 v4, v5
    v_add_f32 v4, v4, v5
    v_mov_b32 v5, v4
    s_nop 1
    v_permlane16_swap_b32 v4, v5
    v_add_f32 v4, v4, v5
    v_rcp_f32 v4, v4
    s_nop 0
    v_mov_b32 v5, v4
    s_nop 1
    v_permlane32_swap_b32 v4, v5
    v_mul_f32 v92, v92, v4
    v_mul_f32 v93, v93, v4
    v_mul_f32 v94, v94, v4
    v_mul_f32 v95, v95, v4
    v_cvt_pk_bf16_f32 v56, v92, v93
    v_cvt_pk_bf16_f32 v57, v94, v95
    v_mul_f32 v96, v96, v4
    v_mul_f32 v97, v97, v4
    v_mul_f32 v98, v98, v4
    v_mul_f32 v99, v99, v4
    v_cvt_pk_bf16_f32 v58, v96, v97
    v_cvt_pk_bf16_f32 v59, v98, v99
    v_mul_f32 v100, v100, v5
    v_mul_f32 v101, v101, v5
    v_mul_f32 v102, v102, v5
    v_mul_f32 v103, v103, v5
    v_cvt_pk_bf16_f32 v60, v100, v101
    v_cvt_pk_bf16_f32 v61, v102, v103
    v_mul_f32 v104, v104, v5
    v_mul_f32 v105, v105, v5
    v_mul_f32 v106, v106, v5
    v_mul_f32 v107, v107, v5
    v_cvt_pk_bf16_f32 v62, v104, v105
    v_cvt_pk_bf16_f32 v63, v106, v107
    s_waitcnt vmcnt(1)
pc_51:
    v_max3_u32 v4, v168, v172, v176
    v_max3_u32 v4, v4, v180, v184
    v_max3_u32 v4, v4, v188, v192
    v_max_u32 v4, v4, v196
    v_cmp_eq_u32 vcc, -1, v4
    s_cbranch_vccz pd_52
    s_cmp_eq_u32 s11, 0
    s_cbranch_scc1 pd_52
    s_sub_u32 s11, s11, 1
    buffer_load_dwordx4 v[168:171], v1, s[44:47], s20 offen offset:0 sc1
    buffer_load_dwordx4 v[172:175], v1, s[44:47], s20 offen offset:1024 sc1
    buffer_load_dwordx4 v[176:179], v1, s[44:47], s20 offen offset:2048 sc1
    buffer_load_dwordx4 v[180:183], v1, s[44:47], s20 offen offset:3072 sc1
    buffer_load_dwordx4 v[184:187], v1, s[44:47], s14 offen offset:0 sc1
    buffer_load_dwordx4 v[188:191], v1, s[44:47], s14 offen offset:1024 sc1
    buffer_load_dwordx4 v[192:195], v1, s[44:47], s14 offen offset:2048 sc1
    buffer_load_dwordx4 v[196:199], v1, s[44:47], s14 offen offset:3072 sc1
    s_waitcnt vmcnt(0)
    s_branch pc_51
pd_52:
    v_mfma_f32_16x16x32_bf16 v[132:135], v[128:131], v[168:171], 0
    v_mfma_f32_16x16x32_bf16 v[136:139], v[128:131], v[172:175], 0
    v_mfma_f32_16x16x32_bf16 v[132:135], v[128:131], v[176:179], v[132:135]
    v_mfma_f32_16x16x32_bf16 v[136:139], v[128:131], v[180:183], v[136:139]
    v_mfma_f32_16x16x32_bf16 v[132:135], v[128:131], v[184:187], v[132:135]
    v_mfma_f32_16x16x32_bf16 v[136:139], v[128:131], v[188:191], v[136:139]
    v_mfma_f32_16x16x32_bf16 v[132:135], v[128:131], v[192:195], v[132:135]
    v_mfma_f32_16x16x32_bf16 v[136:139], v[128:131], v[196:199], v[136:139]
    s_nop 7
    v_pk_add_f32 v[132:133], v[132:133], v[136:137]
    v_pk_add_f32 v[134:135], v[134:135], v[138:139]
    v_cvt_pk_bf16_f32 v132, v132, v133
    v_cvt_pk_bf16_f32 v133, v134, v135
    ds_write_b64 v45, v[132:133] offset:0
    s_cmp_lg_u32 s6, 7
    s_cbranch_scc0 en7_53
en7_53:
    s_cmp_eq_u32 s6, 7
    s_cselect_b32 s26, 4, s3
    s_cmp_lt_u32 s26, 4
    s_cbranch_scc0 en7l2_54
    s_add_u32 m0, s18, 8192
    s_add_u32 s12, s16, 344064
    buffer_load_dwordx4 v14, s[60:63], s12 offen lds
    s_add_u32 m0, s18, 16384
    s_add_u32 s12, s16, 401408
    buffer_load_dwordx4 v14, s[60:63], s12 offen lds
    s_add_u32 m0, s18, 24576
    s_add_u32 s12, s16, 458752
    buffer_load_dwordx4 v14, s[60:63], s12 offen lds
    s_add_u32 m0, s18, 32768
    s_add_u32 s12, s16, 516096
    buffer_load_dwordx4 v14, s[60:63], s12 offen lds
    s_add_u32 m0, s18, 40960
    s_add_u32 s12, s16, 573440
    buffer_load_dwordx4 v14, s[60:63], s12 offen lds
    s_add_u32 m0, s18, 139264
    s_add_u32 s12, s16, 630784
    buffer_load_dwordx4 v14, s[60:63], s12 offen lds
en7l2_54:
    s_waitcnt lgkmcnt(0)
    s_barrier
    ds_read_b128 v[64:67], v1 offset:0
    ds_read_b128 v[68:71], v1 offset:6144
    ds_read_b128 v[72:75], v1 offset:1024
    ds_read_b128 v[76:79], v1 offset:7168
    s_waitcnt lgkmcnt(1)
    v_mfma_f32_16x16x32_bf16 v[84:87], v[72:75], v[56:59], 0
    s_waitcnt lgkmcnt(0)
    v_mfma_f32_16x16x32_bf16 v[84:87], v[76:79], v[60:63], v[84:87]
    v_mfma_f32_16x16x32_bf16 v[80:83], v[64:67], v[56:59], 0
    v_mfma_f32_16x16x32_bf16 v[80:83], v[68:71], v[60:63], v[80:83]
    ds_read_b64_tr_b16 v[88:89], v46 offset:0
    ds_read_b64_tr_b16 v[90:91], v46 offset:2048
    ds_read_b64_tr_b16 v[92:93], v46 offset:512
    ds_read_b64_tr_b16 v[94:95], v46 offset:2560
    s_nop 1
    v_mov_b32 v4, v84
    v_mov_b32 v5, v84
    s_nop 1
    v_permlane32_swap_b32 v4, v5
    v_mov_b32 v4, v5
    ds_read_b64_tr_b16 v[96:97], v46 offset:1024
    ds_read_b64_tr_b16 v[98:99], v46 offset:3072
    v_permlane16_swap_b32 v4, v5
    v_add_f32 v4, 0x358637bd, v5
    v_rcp_f32 v4, v4
    ds_read_b64_tr_b16 v[100:101], v46 offset:3584
    ds_read_b64_tr_b16 v[102:103], v46 offset:5632
    v_mul_f32 v80, v80, v4
    v_mul_f32 v81, v81, v4
    v_mul_f32 v82, v82, v4
    v_mul_f32 v83, v83, v4
    v_mul_f32 v84, v84, v4
    v_mul_f32 v85, v85, v4
    v_mul_f32 v86, v86, v4
    v_mul_f32 v87, v87, v4
    v_cvt_pk_bf16_f32 v80, v80, v81
    v_cvt_pk_bf16_f32 v81, v82, v83
    v_cvt_pk_bf16_f32 v82, v84, v85
    v_cvt_pk_bf16_f32 v83, v86, v87
    s_not_b64 exec, s[24:25]
    buffer_store_dwordx4 v[80:83], v1, s[44:47], s21 offen sc1
    s_mov_b64 exec, s[24:25]
    buffer_store_dwordx2 v[80:81], v1, s[44:47], s22 offen sc1
    s_mov_b64 exec, -1
    s_cmp_eq_u32 s6, 7
    s_cbranch_scc1 fin7
    ds_read_b64_tr_b16 v[104:105], v46 offset:4096
    ds_read_b64_tr_b16 v[106:107], v46 offset:6144
    ds_read_b64_tr_b16 v[108:109], v46 offset:4608
    ds_read_b64_tr_b16 v[110:111], v46 offset:6656
    ds_read_b64_tr_b16 v[112:113], v46 offset:1536
    ds_read_b64_tr_b16 v[114:115], v46 offset:5120
    ds_read_b64_tr_b16 v[116:117], v47 offset:0
    ds_read_b64_tr_b16 v[118:119], v47 offset:2048
    s_add_u32 m0, s18, 147456
    s_add_u32 s12, s16, 688128
    buffer_load_dwordx4 v14, s[60:63], s12 offen lds
    s_add_u32 m0, s18, 155648
    s_add_u32 s12, s16, 745472
    buffer_load_dwordx4 v14, s[60:63], s12 offen lds
    s_add_u32 m0, s18, 77824
    s_add_u32 s12, s16, 802816
    buffer_load_dwordx4 v14, s[60:63], s12 offen lds
    s_add_u32 m0, s18, 86016
    s_add_u32 s12, s16, 860160
    buffer_load_dwordx4 v14, s[60:63], s12 offen lds
    s_add_u32 m0, s18, 94208
    s_add_u32 s12, s16, 917504
    buffer_load_dwordx4 v14, s[60:63], s12 offen lds
    s_add_u32 m0, s18, 102400
    s_add_u32 s12, s16, 974848
    buffer_load_dwordx4 v14, s[60:63], s12 offen lds
    v_mov_b32 v5, s10
    s_waitcnt vmcnt(8)
pc_55:
    v_xor_b32 v4, v29, v5
    v_bitop3_b32 v4, v4, v31, v5 bitop3:0xf6
    v_cmp_ne_u32 vcc, 0, v4
    s_cbranch_vccz pd_56
    s_cmp_eq_u32 s11, 0
    s_cbranch_scc1 pd_56
    s_sub_u32 s11, s11, 1
    buffer_load_dwordx4 v[28:31], v12, s[44:47], s15 offen sc1
    s_waitcnt vmcnt(0)
    s_branch pc_55
pd_56:
    v_cvt_pk_bf16_f32 v28, v28, v30
    ds_write_b32 v44, v28 offset:2048
    v_mov_b32 v4, 0
    v_mov_b32 v5, 0
    v_mov_b32 v6, 0
    v_mov_b32 v7, 0
    v_min_u32 v8, 27, v2
    v_mul_u32_u24 v8, 80, v8
    ds_write_b128 v8, v[4:7] offset:2112
    ds_read_b64_tr_b16 v[120:121], v47 offset:512
    ds_read_b64_tr_b16 v[122:123], v47 offset:2560
    ds_read_b64_tr_b16 v[124:125], v47 offset:1024
    ds_read_b64_tr_b16 v[126:127], v47 offset:3072
    ds_read_b64_tr_b16 v[128:129], v47 offset:3584
    ds_read_b64_tr_b16 v[130:131], v47 offset:5632
    ds_read_b64_tr_b16 v[132:133], v47 offset:4096
    ds_read_b64_tr_b16 v[134:135], v47 offset:6144
    ds_read_b64_tr_b16 v[136:137], v47 offset:4608
    ds_read_b64_tr_b16 v[138:139], v47 offset:6656
    ds_read_b64_tr_b16 v[140:141], v47 offset:1536
    ds_read_b64_tr_b16 v[142:143], v47 offset:5120
    s_and_b32 s13, s3, 6
    s_lshl3_add_u32 s14, s4, s13
    s_add_u32 s14, s14, s7
    s_lshl_b32 s14, s14, 1
    s_and_b32 s13, s3, 1
    s_add_u32 s14, s14, s13
    s_mul_i32 s14, s14, 7168
    s_add_u32 s74, s14, 2097152
    s_mul_i32 s12, s8, 7168
    s_cmp_lt_u32 s3, 4
    s_mov_b32 s13, 49152
    s_cmov_b32 s13, 110592
    s_add_u32 s75, s12, s13
    s_waitcnt vmcnt(0)
    s_waitcnt lgkmcnt(0)
    s_barrier
    s_add_u32 m0, s75, 0
    s_add_u32 s12, s74, 0
    buffer_load_dwordx4 v1, s[44:47], s12 offen sc1 lds
    s_add_u32 m0, s75, 1024
    s_add_u32 s12, s74, 1024
    buffer_load_dwordx4 v1, s[44:47], s12 offen sc1 lds
    s_add_u32 m0, s75, 2048
    s_add_u32 s12, s74, 2048
    buffer_load_dwordx4 v1, s[44:47], s12 offen sc1 lds
    s_add_u32 m0, s75, 3072
    s_add_u32 s12, s74, 3072
    buffer_load_dwordx4 v1, s[44:47], s12 offen sc1 lds
    s_add_u32 m0, s75, 4096
    s_add_u32 s12, s74, 4096
    buffer_load_dwordx4 v1, s[44:47], s12 offen sc1 lds
    s_add_u32 m0, s75, 5120
    s_add_u32 s12, s74, 5120
    buffer_load_dwordx4 v1, s[44:47], s12 offen sc1 lds
    s_add_u32 m0, s75, 6144
    s_add_u32 s12, s74, 6144
    buffer_load_dwordx4 v1, s[44:47], s12 offen sc1 lds
    v_lshrrev_b32 v4, 8, v1
    v_and_b32 v5, 0xf0, v1
    s_lshl_b32 s12, s8, 5
    s_add_u32 s12, s12, 4352
    v_lshl_add_u32 v6, v4, 3, s12
    ds_read2_b64 v[16:19], v6 offset0:0 offset1:16
    s_lshl2_add_u32 s12, s6, s8
    s_mul_i32 s13, s12, 80
    s_sub_u32 s13, 4208, s13
    v_lshl_add_u32 v7, v3, 3, s13
    v_bfe_u32 v8, v1, 8, 1
    v_lshl_add_u32 v7, v8, 4, v7
    ds_read_b64 v[20:21], v7
    s_lshr_b32 s13, s3, 2
    s_lshl2_add_u32 s14, s4, s13
    s_lshl1_add_u32 s14, s14, s7
    s_mul_i32 s14, s14, 14336
    s_lshl_b32 s12, s12, 5
    s_add_u32 s72, s14, s12
    s_add_u32 s73, s72, 57344
    v_subrev_u32 v0, 32768, v10
    ds_read_b64_tr_b16 v[168:169], v0 offset:0
    ds_read_b64_tr_b16 v[170:171], v0 offset:2048
    ds_read_b64_tr_b16 v[172:173], v0 offset:8192
    ds_read_b64_tr_b16 v[174:175], v0 offset:10240
    ds_read_b64_tr_b16 v[176:177], v0 offset:16384
    ds_read_b64_tr_b16 v[178:179], v0 offset:18432
    ds_read_b64_tr_b16 v[180:181], v0 offset:24576
    ds_read_b64_tr_b16 v[182:183], v0 offset:26624
    ds_read_b64_tr_b16 v[184:185], v10 offset:0
    ds_read_b64_tr_b16 v[186:187], v10 offset:2048
    ds_read_b64_tr_b16 v[188:189], v11 offset:36864
    ds_read_b64_tr_b16 v[190:191], v11 offset:38912
    ds_read_b64_tr_b16 v[192:193], v11 offset:45056
    ds_read_b64_tr_b16 v[194:195], v11 offset:47104
    ds_read_b64_tr_b16 v[196:197], v11 offset:53248
    ds_read_b64_tr_b16 v[198:199], v11 offset:55296
    v_bfe_u32 v8, v1, 4, 4
    v_bfe_u32 v9, v1, 8, 1
    v_lshlrev_b32 v9, 2, v9
    v_sub_u32 v8, v8, v9
    v_lshlrev_b32 v9, 4, v3
    v_lshl_add_u32 v9, v8, 5, v9
    v_cmp_gt_u32 vcc, 2, v8
    s_nop 1
    v_cndmask_b32 v2, 64, v9, vcc
    v_add_u32 v2, 2048, v2
    v_add_u32 v9, s75, v1
    ds_read_b64_tr_b16 v[200:201], v10 offset:36864
    ds_read_b64_tr_b16 v[202:203], v10 offset:38912
    ds_read_b64_tr_b16 v[204:205], v10 offset:45056
    ds_read_b64_tr_b16 v[206:207], v10 offset:47104
    ds_read_b64_tr_b16 v[208:209], v10 offset:53248
    ds_read_b64_tr_b16 v[210:211], v10 offset:55296
    ds_read_b64_tr_b16 v[212:213], v11 offset:0
    ds_read_b64_tr_b16 v[214:215], v11 offset:2048
    ds_read_b128 v[40:43], v2 offset:2160
    ds_read_b128 v[44:47], v2 offset:2080
    ds_read_b128 v[56:59], v2 offset:2000
    s_waitcnt lgkmcnt(2)
    v_mfma_f32_16x16x32_bf16 v[52:55], v[40:43], v[144:147], 0
    ds_read_b128 v[40:43], v2 offset:1920
    s_waitcnt lgkmcnt(2)
    v_mfma_f32_16x16x32_bf16 v[84:87], v[44:47], v[148:151], 0
    ds_read_b128 v[44:47], v2 offset:1840
    s_waitcnt lgkmcnt(2)
    v_mfma_f32_16x16x32_bf16 v[52:55], v[56:59], v[152:155], v[52:55]
    ds_read_b128 v[56:59], v2 offset:1760
    s_waitcnt lgkmcnt(2)
    v_mfma_f32_16x16x32_bf16 v[84:87], v[40:43], v[156:159], v[84:87]
    ds_read_b128 v[40:43], v2 offset:1680
    s_waitcnt lgkmcnt(2)
    v_mfma_f32_16x16x32_bf16 v[52:55], v[44:47], v[160:163], v[52:55]
    ds_read_b128 v[44:47], v2 offset:1600
    s_waitcnt lgkmcnt(2)
    v_mfma_f32_16x16x32_bf16 v[84:87], v[56:59], v[164:167], v[84:87]
    ds_read_b128 v[56:59], v2 offset:1520
    s_waitcnt lgkmcnt(2)
    v_mfma_f32_16x16x32_bf16 v[52:55], v[40:43], v[168:171], v[52:55]
    ds_read_b128 v[40:43], v2 offset:1440
    s_waitcnt lgkmcnt(2)
    v_mfma_f32_16x16x32_bf16 v[84:87], v[44:47], v[172:175], v[84:87]
    ds_read_b128 v[44:47], v2 offset:1360
    s_waitcnt lgkmcnt(2)
    v_mfma_f32_16x16x32_bf16 v[52:55], v[56:59], v[176:179], v[52:55]
    ds_read_b128 v[56:59], v2 offset:1280
    s_waitcnt lgkmcnt(2)
    v_mfma_f32_16x16x32_bf16 v[84:87], v[40:43], v[180:183], v[84:87]
    s_waitcnt lgkmcnt(1)
    v_mfma_f32_16x16x32_bf16 v[52:55], v[44:47], v[184:187], v[52:55]
    s_waitcnt lgkmcnt(0)
    v_mfma_f32_16x16x32_bf16 v[84:87], v[56:59], v[188:191], v[84:87]
    v_bfe_u32 v8, v1, 8, 1
    v_mul_u32_u24 v22, 57344, v8
    v_lshl_add_u32 v22, v3, 8, v22
    v_and_b32 v8, 0xf0, v1
    v_add_u32 v22, v22, v8
    s_mul_i32 s43, s7, 7
    s_add_u32 s43, s43, s6
    s_lshl_b32 s43, s43, 3
    s_add_u32 s43, s43, s3
    s_lshl_b32 s43, s43, 9
    s_mul_i32 s13, s4, 458752
    s_add_u32 s43, s43, s13
    s_add_u32 s43, s43, 8388608
    s_cmp_eq_u32 s6, 7
    s_cselect_b32 s43, 0x7f000000, s43
    v_mov_b32 v24, -1
    v_mov_b32 v25, -1
    v_mov_b32 v26, -1
    v_mov_b32 v27, -1
    buffer_store_dwordx4 v[24:27], v22, s[44:47], s43 offen sc1
    s_add_u32 s12, s43, 114688
    buffer_store_dwordx4 v[24:27], v22, s[44:47], s12 offen sc1
    s_add_u32 s12, s43, 229376
    buffer_store_dwordx4 v[24:27], v22, s[44:47], s12 offen sc1
    s_add_u32 s12, s43, 344064
    buffer_store_dwordx4 v[24:27], v22, s[44:47], s12 offen sc1
    ds_read_b128 v[40:43], v2 offset:1200
    ds_read_b128 v[44:47], v2 offset:1120
    ds_read_b128 v[56:59], v2 offset:1040
    s_waitcnt lgkmcnt(2)
    v_mfma_f32_16x16x32_bf16 v[52:55], v[40:43], v[192:195], v[52:55]
    ds_read_b128 v[40:43], v2 offset:960
    s_waitcnt lgkmcnt(2)
    v_mfma_f32_16x16x32_bf16 v[84:87], v[44:47], v[196:199], v[84:87]
    ds_read_b128 v[44:47], v2 offset:880
    s_waitcnt lgkmcnt(2)
    v_mfma_f32_16x16x32_bf16 v[52:55], v[56:59], v[200:203], v[52:55]
    ds_read_b128 v[56:59], v2 offset:800
    s_waitcnt lgkmcnt(2)
    v_mfma_f32_16x16x32_bf16 v[84:87], v[40:43], v[204:207], v[84:87]
    s_waitcnt lgkmcnt(1)
    v_mfma_f32_16x16x32_bf16 v[52:55], v[44:47], v[208:211], v[52:55]
    s_waitcnt lgkmcnt(0)
    v_mfma_f32_16x16x32_bf16 v[84:87], v[56:59], v[212:215], v[84:87]
    v_mul_u32_u24 v12, 3584, v4
    v_add_u32 v12, v12, v5
    s_lshr_b32 s13, s3, 2
    s_mul_i32 s13, s13, 14336
    s_add_u32 s13, s13, 49152
    v_add_u32 v13, s13, v12
    v_add_u32 v12, 61440, v13
    v_mul_u32_u24 v7, 56832, v3
    v_bfe_u32 v8, v1, 8, 1
    v_lshl_add_u32 v7, v8, 8, v7
    v_add_u32 v7, v7, v1
    s_lshl_b32 s14, s4, 2
    s_lshr_b32 s13, s3, 2
    s_add_u32 s14, s14, s13
    s_mul_i32 s14, s14, 28
    s_lshl_b32 s13, s6, 2
    s_add_u32 s14, s14, s13
    s_add_u32 s14, s14, s8
    s_lshl_b32 s14, s14, 2
    s_add_u32 s14, s14, s7
    s_lshl_b32 s14, s14, 8
    s_add_u32 s14, s14, 4194304
    s_cmp_eq_u32 s6, 7
    s_cselect_b32 s14, 0x7f000000, s14
    v_lshlrev_b32 v56, 16, v48
    v_and_b32 v57, 0xffff0000, v48
    v_lshlrev_b32 v58, 16, v49
    v_and_b32 v59, 0xffff0000, v49
    v_lshlrev_b32 v60, 16, v50
    v_and_b32 v61, 0xffff0000, v50
    v_lshlrev_b32 v62, 16, v51
    v_and_b32 v63, 0xffff0000, v51
    v_lshlrev_b32 v76, 16, v16
    v_and_b32 v77, 0xffff0000, v16
    v_lshlrev_b32 v78, 16, v17
    v_and_b32 v79, 0xffff0000, v17
    v_lshlrev_b32 v64, 16, v18
    v_and_b32 v65, 0xffff0000, v18
    v_lshlrev_b32 v66, 16, v19
    v_and_b32 v67, 0xffff0000, v19
    v_lshlrev_b32 v80, 16, v20
    v_and_b32 v81, 0xffff0000, v20
    v_lshlrev_b32 v82, 16, v21
    v_and_b32 v83, 0xffff0000, v21
    s_waitcnt vmcnt(4)
    ds_read_b128 v[16:19], v9 offset:0
    ds_read_b128 v[20:23], v9 offset:1024
    ds_read_b128 v[24:27], v9 offset:2048
    ds_read_b128 v[28:31], v9 offset:3072
    ds_read_b128 v[32:35], v9 offset:4096
    ds_read_b128 v[36:39], v9 offset:5120
    ds_read_b128 v[40:43], v9 offset:6144
    s_waitcnt lgkmcnt(5)
    v_max3_u32 v8, v16, v18, v20
    s_waitcnt lgkmcnt(4)
    v_max3_u32 v8, v8, v22, v24
    s_waitcnt lgkmcnt(3)
    v_max3_u32 v8, v8, v26, v28
    s_waitcnt lgkmcnt(2)
    v_max3_u32 v8, v8, v30, v32
    s_waitcnt lgkmcnt(1)
    v_max3_u32 v8, v8, v34, v36
    s_waitcnt lgkmcnt(0)
    v_max3_u32 v8, v8, v38, v40
    v_max_u32 v8, v8, v42
    v_cmp_eq_u32 vcc, -1, v8
    s_cbranch_vccz pd_58
pc_57:
    s_cmp_eq_u32 s11, 0
    s_cbranch_scc1 pd_58
    s_sub_u32 s11, s11, 1
    v_max_u32 v8, v16, v18
    v_cmp_eq_u32 vcc, -1, v8
    s_cbranch_vccz ps_59
    s_add_u32 m0, s75, 0
    s_add_u32 s12, s74, 0
    buffer_load_dwordx4 v1, s[44:47], s12 offen sc1 lds
ps_59:
    v_max_u32 v8, v20, v22
    v_cmp_eq_u32 vcc, -1, v8
    s_cbranch_vccz ps_60
    s_add_u32 m0, s75, 1024
    s_add_u32 s12, s74, 1024
    buffer_load_dwordx4 v1, s[44:47], s12 offen sc1 lds
ps_60:
    v_max_u32 v8, v24, v26
    v_cmp_eq_u32 vcc, -1, v8
    s_cbranch_vccz ps_61
    s_add_u32 m0, s75, 2048
    s_add_u32 s12, s74, 2048
    buffer_load_dwordx4 v1, s[44:47], s12 offen sc1 lds
ps_61:
    v_max_u32 v8, v28, v30
    v_cmp_eq_u32 vcc, -1, v8
    s_cbranch_vccz ps_62
    s_add_u32 m0, s75, 3072
    s_add_u32 s12, s74, 3072
    buffer_load_dwordx4 v1, s[44:47], s12 offen sc1 lds
ps_62:
    v_max_u32 v8, v32, v34
    v_cmp_eq_u32 vcc, -1, v8
    s_cbranch_vccz ps_63
    s_add_u32 m0, s75, 4096
    s_add_u32 s12, s74, 4096
    buffer_load_dwordx4 v1, s[44:47], s12 offen sc1 lds
ps_63:
    v_max_u32 v8, v36, v38
    v_cmp_eq_u32 vcc, -1, v8
    s_cbranch_vccz ps_64
    s_add_u32 m0, s75, 5120
    s_add_u32 s12, s74, 5120
    buffer_load_dwordx4 v1, s[44:47], s12 offen sc1 lds
ps_64:
    v_max_u32 v8, v40, v42
    v_cmp_eq_u32 vcc, -1, v8
    s_cbranch_vccz ps_65
    s_add_u32 m0, s75, 6144
    s_add_u32 s12, s74, 6144
    buffer_load_dwordx4 v1, s[44:47], s12 offen sc1 lds
ps_65:
    s_waitcnt vmcnt(0)
    ds_read_b128 v[16:19], v9 offset:0
    ds_read_b128 v[20:23], v9 offset:1024
    ds_read_b128 v[24:27], v9 offset:2048
    ds_read_b128 v[28:31], v9 offset:3072
    ds_read_b128 v[32:35], v9 offset:4096
    ds_read_b128 v[36:39], v9 offset:5120
    ds_read_b128 v[40:43], v9 offset:6144
    s_waitcnt lgkmcnt(5)
    v_max3_u32 v8, v16, v18, v20
    s_waitcnt lgkmcnt(4)
    v_max3_u32 v8, v8, v22, v24
    s_waitcnt lgkmcnt(3)
    v_max3_u32 v8, v8, v26, v28
    s_waitcnt lgkmcnt(2)
    v_max3_u32 v8, v8, v30, v32
    s_waitcnt lgkmcnt(1)
    v_max3_u32 v8, v8, v34, v36
    s_waitcnt lgkmcnt(0)
    v_max3_u32 v8, v8, v38, v40
    v_max_u32 v8, v8, v42
    v_cmp_eq_u32 vcc, -1, v8
    s_waitcnt lgkmcnt(0)
    s_cbranch_vccnz pc_57
    s_nop 4
pd_58:
    s_barrier
    ds_read_b128 v[16:19], v12 offset:0
    ds_read_b128 v[20:23], v13 offset:0
    ds_read_b128 v[24:27], v12 offset:256
    ds_read_b128 v[28:31], v13 offset:256
    ds_read_b128 v[32:35], v12 offset:512
    ds_read_b128 v[36:39], v13 offset:512
    s_waitcnt lgkmcnt(5)
    v_mfma_f32_16x16x32_bf16 v[68:71], v[88:91], v[16:19], 0
    s_waitcnt lgkmcnt(4)
    v_mfma_f32_16x16x32_bf16 v[72:75], v[88:91], v[20:23], 0
    ds_read_b128 v[16:19], v12 offset:768
    s_waitcnt lgkmcnt(4)
    v_mfma_f32_16x16x32_bf16 v[68:71], v[92:95], v[24:27], v[68:71]
    ds_read_b128 v[20:23], v13 offset:768
    s_waitcnt lgkmcnt(4)
    v_mfma_f32_16x16x32_bf16 v[72:75], v[92:95], v[28:31], v[72:75]
    ds_read_b128 v[24:27], v12 offset:1024
    s_waitcnt lgkmcnt(4)
    v_mfma_f32_16x16x32_bf16 v[68:71], v[96:99], v[32:35], v[68:71]
    ds_read_b128 v[28:31], v13 offset:1024
    s_waitcnt lgkmcnt(4)
    v_mfma_f32_16x16x32_bf16 v[72:75], v[96:99], v[36:39], v[72:75]
    ds_read_b128 v[32:35], v12 offset:1280
    s_waitcnt lgkmcnt(4)
    v_mfma_f32_16x16x32_bf16 v[68:71], v[100:103], v[16:19], v[68:71]
    ds_read_b128 v[36:39], v13 offset:1280
    s_waitcnt lgkmcnt(4)
    v_mfma_f32_16x16x32_bf16 v[72:75], v[100:103], v[20:23], v[72:75]
    ds_read_b128 v[16:19], v12 offset:1536
    s_waitcnt lgkmcnt(4)
    v_mfma_f32_16x16x32_bf16 v[68:71], v[104:107], v[24:27], v[68:71]
    ds_read_b128 v[20:23], v13 offset:1536
    s_waitcnt lgkmcnt(4)
    v_mfma_f32_16x16x32_bf16 v[72:75], v[104:107], v[28:31], v[72:75]
    ds_read_b128 v[24:27], v12 offset:1792
    s_waitcnt lgkmcnt(4)
    v_mfma_f32_16x16x32_bf16 v[68:71], v[108:111], v[32:35], v[68:71]
    ds_read_b128 v[28:31], v13 offset:1792
    s_waitcnt lgkmcnt(4)
    v_mfma_f32_16x16x32_bf16 v[72:75], v[108:111], v[36:39], v[72:75]
    ds_read_b128 v[32:35], v12 offset:2048
    s_waitcnt lgkmcnt(4)
    v_mfma_f32_16x16x32_bf16 v[68:71], v[112:115], v[16:19], v[68:71]
    ds_read_b128 v[36:39], v13 offset:2048
    s_waitcnt lgkmcnt(4)
    v_mfma_f32_16x16x32_bf16 v[72:75], v[112:115], v[20:23], v[72:75]
    ds_read_b128 v[16:19], v12 offset:2304
    s_waitcnt lgkmcnt(4)
    v_mfma_f32_16x16x32_bf16 v[68:71], v[116:119], v[24:27], v[68:71]
    ds_read_b128 v[20:23], v13 offset:2304
    s_waitcnt lgkmcnt(4)
    v_mfma_f32_16x16x32_bf16 v[72:75], v[116:119], v[28:31], v[72:75]
    ds_read_b128 v[24:27], v12 offset:2560
    s_waitcnt lgkmcnt(4)
    v_mfma_f32_16x16x32_bf16 v[68:71], v[120:123], v[32:35], v[68:71]
    ds_read_b128 v[28:31], v13 offset:2560
    s_waitcnt lgkmcnt(4)
    v_mfma_f32_16x16x32_bf16 v[72:75], v[120:123], v[36:39], v[72:75]
    ds_read_b128 v[32:35], v12 offset:2816
    s_add_u32 m0, s18, 8192
    s_add_u32 s12, s16, 1032192
    buffer_load_dwordx4 v14, s[60:63], s12 offen lds
    s_waitcnt lgkmcnt(4)
    v_mfma_f32_16x16x32_bf16 v[68:71], v[124:127], v[16:19], v[68:71]
    ds_read_b128 v[36:39], v13 offset:2816
    s_add_u32 m0, s18, 16384
    s_add_u32 s12, s16, 1089536
    buffer_load_dwordx4 v14, s[60:63], s12 offen lds
    s_waitcnt lgkmcnt(4)
    v_mfma_f32_16x16x32_bf16 v[72:75], v[124:127], v[20:23], v[72:75]
    ds_read_b128 v[16:19], v12 offset:3072
    s_add_u32 m0, s18, 24576
    s_add_u32 s12, s16, 1146880
    buffer_load_dwordx4 v14, s[60:63], s12 offen lds
    s_waitcnt lgkmcnt(4)
    v_mfma_f32_16x16x32_bf16 v[68:71], v[128:131], v[24:27], v[68:71]
    ds_read_b128 v[20:23], v13 offset:3072
    s_add_u32 m0, s18, 32768
    s_add_u32 s12, s16, 1204224
    buffer_load_dwordx4 v14, s[60:63], s12 offen lds
    s_waitcnt lgkmcnt(4)
    v_mfma_f32_16x16x32_bf16 v[72:75], v[128:131], v[28:31], v[72:75]
    ds_read_b128 v[24:27], v12 offset:3328
    s_add_u32 m0, s18, 77824
    s_add_u32 s12, s16, 1261568
    buffer_load_dwordx4 v14, s[60:63], s12 offen lds
    s_waitcnt lgkmcnt(4)
    v_mfma_f32_16x16x32_bf16 v[68:71], v[132:135], v[32:35], v[68:71]
    ds_read_b128 v[28:31], v13 offset:3328
    s_add_u32 m0, s18, 86016
    s_add_u32 s12, s16, 1318912
    buffer_load_dwordx4 v14, s[60:63], s12 offen lds
    s_waitcnt lgkmcnt(4)
    v_mfma_f32_16x16x32_bf16 v[72:75], v[132:135], v[36:39], v[72:75]
    s_add_u32 m0, s18, 94208
    s_add_u32 s12, s16, 1376256
    buffer_load_dwordx4 v14, s[60:63], s12 offen lds
    s_waitcnt lgkmcnt(3)
    v_mfma_f32_16x16x32_bf16 v[68:71], v[136:139], v[16:19], v[68:71]
    s_add_u32 m0, s18, 102400
    s_add_u32 s12, s16, 1433600
    buffer_load_dwordx4 v14, s[60:63], s12 offen lds
    s_waitcnt lgkmcnt(2)
    v_mfma_f32_16x16x32_bf16 v[72:75], v[136:139], v[20:23], v[72:75]
    s_add_u32 m0, s18, 147456
    s_add_u32 s12, s16, 1490944
    buffer_load_dwordx4 v14, s[60:63], s12 offen lds
    s_waitcnt lgkmcnt(1)
    v_mfma_f32_16x16x32_bf16 v[68:71], v[140:143], v[24:27], v[68:71]
    s_add_u32 m0, s18, 155648
    s_add_u32 s12, s16, 1548288
    buffer_load_dwordx4 v14, s[60:63], s12 offen lds
    s_waitcnt lgkmcnt(0)
    v_mfma_f32_16x16x32_bf16 v[72:75], v[140:143], v[28:31], v[72:75]
    s_nop 2
    v_pk_fma_f32 v[56:57], v[76:77], v[68:69], v[56:57]
    v_pk_fma_f32 v[58:59], v[78:79], v[70:71], v[58:59]
    s_nop 2
    v_pk_fma_f32 v[60:61], v[76:77], v[72:73], v[60:61]
    v_pk_fma_f32 v[62:63], v[78:79], v[74:75], v[62:63]
    v_pk_mul_f32 v[68:69], v[56:57], v[80:81]
    v_pk_mul_f32 v[70:71], v[58:59], v[82:83]
    v_pk_mul_f32 v[72:73], v[60:61], v[80:81]
    v_pk_mul_f32 v[74:75], v[62:63], v[82:83]
    v_cvt_pk_bf16_f32 v16, v68, v69
    v_cvt_pk_bf16_f32 v17, v70, v71
    v_cvt_pk_bf16_f32 v18, v72, v73
    v_cvt_pk_bf16_f32 v19, v74, v75
    v_cvt_pk_bf16_f32 v48, v56, v57
    v_cvt_pk_bf16_f32 v49, v58, v59
    v_cvt_pk_bf16_f32 v50, v60, v61
    v_cvt_pk_bf16_f32 v51, v62, v63
    v_permlane32_swap_b32 v16, v18
    v_permlane32_swap_b32 v17, v19
    buffer_store_dwordx4 v[16:19], v7, s[44:47], s42 offen sc1
    s_mov_b32 s13, 0x3f803f80
    v_dot2_f32_bf16 v20, v48, s13, 0
    v_dot2_f32_bf16 v22, v48, v48, 0
    v_dot2_f32_bf16 v20, v49, s13, v20
    v_dot2_f32_bf16 v22, v49, v49, v22
    v_dot2_f32_bf16 v21, v50, s13, 0
    v_dot2_f32_bf16 v23, v50, v50, 0
    v_dot2_f32_bf16 v21, v51, s13, v21
    v_dot2_f32_bf16 v23, v51, v51, v23
    s_nop 1
    v_permlane32_swap_b32 v20, v21
    v_permlane32_swap_b32 v22, v23
    v_add_f32 v20, v20, v21
    v_add_f32 v22, v22, v23
    s_nop 1
    v_permlane16_swap_b32 v20, v22
    v_add_f32 v20, v20, v22
    s_lshl_b32 s12, s3, 8
    v_lshrrev_b32 v8, 2, v1
    v_add_u32 v8, s12, v8
    ds_write_b32 v8, v20 offset:0
    s_waitcnt vmcnt(11)
    s_waitcnt lgkmcnt(0)
    s_barrier
    s_cmp_eq_u32 s3, 0
    s_cbranch_scc0 ew0_66
    v_bfe_u32 v8, v1, 8, 1
    v_lshlrev_b32 v8, 10, v8
    v_lshl_add_u32 v8, v3, 7, v8
    v_bfe_u32 v9, v1, 4, 4
    v_lshl_add_u32 v8, v9, 2, v8
    ds_read2_b32 v[16:17], v8 offset0:0 offset1:16
    ds_read2_b32 v[18:19], v8 offset0:64 offset1:80
    ds_read2_b32 v[20:21], v8 offset0:128 offset1:144
    ds_read2_b32 v[22:23], v8 offset0:192 offset1:208
    v_lshrrev_b32 v9, 1, v1
    s_lshl_b32 s12, s4, 4
    s_add_u32 s12, s12, s5
    s_lshl_b32 s12, s12, 9
    s_add_u32 s12, s12, 6029312
    s_cmp_eq_u32 s6, 7
    s_cselect_b32 s12, 0x7f000000, s12
    s_waitcnt lgkmcnt(2)
    v_pk_add_f32 v[16:17], v[16:17], v[18:19]
    s_waitcnt lgkmcnt(0)
    v_pk_add_f32 v[20:21], v[20:21], v[22:23]
    v_pk_add_f32 v[16:17], v[16:17], v[20:21]
    buffer_store_dwordx2 v[16:17], v9, s[44:47], s12 offen sc1
ew0_66:
    s_lshl_b32 s100, s3, 12
    s_mul_i32 s79, s4, 114688
    s_add_u32 s79, s79, s100
    s_add_u32 s79, s79, 4194304
    s_cmp_lt_u32 s3, 2
    s_mov_b32 s12, 135168
    s_cmov_b32 s12, 4096
    s_add_u32 s82, s100, s12
    s_cmp_eq_u32 s3, 7
    s_cmov_b32 s82, 40960
    s_cmov_b32 s79, 0x7f000000
    v_add_u32 v9, s100, v1
    s_mov_b32 s52, s30
    s_mov_b32 s53, s31
    s_mov_b32 s54, 0x188000
    s_mov_b32 s55, 0x20000
    s_mov_b32 s56, s36
    s_mov_b32 s57, s37
    s_mov_b32 s58, 0x1c0000
    s_mov_b32 s59, 0x20000
    v_bfe_u32 v8, v1, 8, 1
    v_mul_u32_u24 v7, 57344, v8
    v_lshl_add_u32 v7, v3, 8, v7
    v_and_b32 v8, 0xf0, v1
    v_add_u32 v7, v7, v8
    s_mul_i32 s14, s7, 7
    s_add_u32 s14, s14, s6
    s_lshl_b32 s14, s14, 3
    s_add_u32 s14, s14, s3
    s_lshl_b32 s14, s14, 9
    s_mul_i32 s13, s4, 458752
    s_add_u32 s14, s14, s13
    s_add_u32 s14, s14, 8388608
    s_cmp_eq_u32 s6, 7
    s_cselect_b32 s14, 0x7f000000, s14
    v_lshrrev_b32 v8, 7, v1
    v_mul_u32_u24 v14, 896, v8
    v_lshrrev_b32 v8, 8, v1
    v_lshlrev_b32 v8, 5, v8
    v_and_b32 v0, 0x70, v1
    v_xor_b32 v8, v8, v0
    v_add_u32 v14, v14, v8
    s_mul_i32 s83, s3, 200704
    s_lshl_b32 s12, s6, 7
    s_add_u32 s83, s83, s12
    s_and_b32 s12, s4, 3
    s_lshl_b32 s12, s12, 11
    s_mov_b32 s26, s12
    s_add_u32 s12, s12, 1024
    s_cmp_eq_u32 s12, 7168
    s_cselect_b32 s12, 0, s12
    s_mov_b32 s27, s12
    s_add_u32 s12, s12, 1024
    s_cmp_eq_u32 s12, 7168
    s_cselect_b32 s12, 0, s12
    s_mov_b32 s28, s12
    s_add_u32 s12, s12, 1024
    s_cmp_eq_u32 s12, 7168
    s_cselect_b32 s12, 0, s12
    s_mov_b32 s29, s12
    s_add_u32 s12, s12, 1024
    s_cmp_eq_u32 s12, 7168
    s_cselect_b32 s12, 0, s12
    s_mov_b32 s30, s12
    s_add_u32 s12, s12, 1024
    s_cmp_eq_u32 s12, 7168
    s_cselect_b32 s12, 0, s12
    s_mov_b32 s31, s12
    s_add_u32 s12, s12, 1024
    s_cmp_eq_u32 s12, 7168
    s_cselect_b32 s12, 0, s12
    s_mov_b32 s32, s12
    s_mul_i32 s81, s4, 458752
    s_mul_i32 s12, s7, 57344
    s_add_u32 s81, s81, s12
    s_mul_i32 s12, s3, 7168
    s_add_u32 s81, s81, s12
    s_add_u32 s81, s81, 8388608
    s_waitcnt vmcnt(1)
    s_barrier
    v_subrev_u32 v0, 32768, v10
    ds_read_b64_tr_b16 v[216:217], v0 offset:0
    ds_read_b64_tr_b16 v[218:219], v0 offset:2048
    ds_read_b64_tr_b16 v[220:221], v0 offset:8192
    ds_read_b64_tr_b16 v[222:223], v0 offset:10240
    ds_read_b64_tr_b16 v[224:225], v0 offset:16384
    ds_read_b64_tr_b16 v[226:227], v0 offset:18432
    ds_read_b64_tr_b16 v[228:229], v0 offset:24576
    ds_read_b64_tr_b16 v[230:231], v0 offset:26624
    ds_read_b64_tr_b16 v[232:233], v10 offset:36864
    ds_read_b64_tr_b16 v[234:235], v10 offset:38912
    ds_read_b64_tr_b16 v[236:237], v10 offset:45056
    ds_read_b64_tr_b16 v[238:239], v10 offset:47104
    ds_read_b64_tr_b16 v[240:241], v10 offset:53248
    ds_read_b64_tr_b16 v[242:243], v10 offset:55296
    ds_read_b64_tr_b16 v[244:245], v11 offset:0
    ds_read_b64_tr_b16 v[246:247], v11 offset:2048
    ds_read_b64_tr_b16 v[248:249], v11 offset:45056
    ds_read_b64_tr_b16 v[250:251], v11 offset:47104
    ds_read_b64_tr_b16 v[252:253], v11 offset:53248
    ds_read_b64_tr_b16 v[254:255], v11 offset:55296
    s_add_u32 m0, s100, 45056
    s_add_u32 s12, s79, 0
    buffer_load_dwordx4 v1, s[44:47], s12 offen sc1 lds
    s_add_u32 m0, s100, 46080
    s_add_u32 s12, s79, 1024
    buffer_load_dwordx4 v1, s[44:47], s12 offen sc1 lds
    s_add_u32 m0, s100, 47104
    s_add_u32 s12, s79, 2048
    buffer_load_dwordx4 v1, s[44:47], s12 offen sc1 lds
    s_add_u32 m0, s100, 48128
    s_add_u32 s12, s79, 3072
    buffer_load_dwordx4 v1, s[44:47], s12 offen sc1 lds
    ds_read_b128 v[40:43], v2 offset:720
    ds_read_b128 v[44:47], v2 offset:640
    ds_read_b128 v[56:59], v2 offset:560
    s_waitcnt lgkmcnt(2)
    v_mfma_f32_16x16x32_bf16 v[52:55], v[40:43], v[216:219], v[52:55]
    ds_read_b128 v[40:43], v2 offset:480
    s_waitcnt lgkmcnt(2)
    v_mfma_f32_16x16x32_bf16 v[84:87], v[44:47], v[220:223], v[84:87]
    ds_read_b128 v[44:47], v2 offset:400
    s_waitcnt lgkmcnt(2)
    v_mfma_f32_16x16x32_bf16 v[52:55], v[56:59], v[224:227], v[52:55]
    ds_read_b128 v[56:59], v2 offset:320
    s_waitcnt lgkmcnt(2)
    v_mfma_f32_16x16x32_bf16 v[84:87], v[40:43], v[228:231], v[84:87]
    ds_read_b128 v[40:43], v2 offset:240
    s_waitcnt lgkmcnt(2)
    v_mfma_f32_16x16x32_bf16 v[52:55], v[44:47], v[232:235], v[52:55]
    ds_read_b128 v[44:47], v2 offset:160
    s_waitcnt lgkmcnt(2)
    v_mfma_f32_16x16x32_bf16 v[84:87], v[56:59], v[236:239], v[84:87]
    ds_read_b128 v[56:59], v2 offset:80
    s_waitcnt lgkmcnt(2)
    v_mfma_f32_16x16x32_bf16 v[52:55], v[40:43], v[240:243], v[52:55]
    ds_read_b128 v[40:43], v2 offset:0
    s_waitcnt lgkmcnt(2)
    v_mfma_f32_16x16x32_bf16 v[84:87], v[44:47], v[244:247], v[84:87]
    s_waitcnt lgkmcnt(1)
    v_mfma_f32_16x16x32_bf16 v[52:55], v[56:59], v[248:251], v[52:55]
    s_waitcnt lgkmcnt(0)
    v_mfma_f32_16x16x32_bf16 v[84:87], v[40:43], v[252:255], v[84:87]
    v_bfe_u32 v8, v1, 6, 2
    v_bfe_u32 v0, v1, 8, 1
    v_lshl_add_u32 v10, v0, 2, v8
    v_lshl_add_u32 v10, v3, 4, v10
    v_bfe_u32 v8, v10, 1, 2
    v_lshlrev_b32 v10, 7, v10
    v_lshl_add_u32 v10, v8, 5, v10
    v_bfe_u32 v8, v1, 4, 2
    v_lshl_add_u32 v10, v8, 3, v10
    v_add_f32 v52, v52, v84
    v_add_f32 v53, v53, v85
    v_cvt_pk_bf16_f32 v54, v52, v53
    v_lshlrev_b32 v84, 16, v54
    v_and_b32 v85, 0xffff0000, v54
    v_sub_f32 v52, v52, v84
    v_sub_f32 v53, v53, v85
    v_cvt_pk_bf16_f32 v52, v52, v53
    v_perm_b32 v84, v52, v54, s38
    v_perm_b32 v85, v54, v52, s39
    v_cndmask_b32_e64 v53, v54, 0, s[76:77]
    v_cndmask_b32_e64 v52, v84, 0, s[76:77]
    v_cndmask_b32_e64 v54, v85, 0, s[76:77]
    v_mov_b32 v55, 0
    s_and_b32 s15, s3, 1
    s_lshl1_add_u32 s15, s4, s15
    s_lshl_b32 s15, s15, 12
    s_lshr_b32 s12, s3, 1
    s_lshl_b32 s12, s12, 7
    s_add_u32 s15, s15, s12
    s_add_u32 s15, s15, 6029312
    v_bfe_u32 v44, v1, 4, 2
    v_lshlrev_b32 v44, 10, v44
    v_lshrrev_b32 v45, 6, v1
    v_lshl_add_u32 v44, v45, 3, v44
    s_waitcnt vmcnt(0)
    v_add_u32 v0, 45056, v9
    ds_read_b32 v16, v0 offset:0
    ds_read_b32 v17, v0 offset:1024
    ds_read_b32 v18, v0 offset:2048
    ds_read_b32 v19, v0 offset:3072
    s_waitcnt lgkmcnt(1)
    v_max3_u32 v8, v16, v17, v18
    s_waitcnt lgkmcnt(0)
    v_max_u32 v8, v8, v19
    v_cmp_eq_u32 vcc, -1, v8
    s_cbranch_vccz pd_68
pc_67:
    s_cmp_eq_u32 s11, 0
    s_cbranch_scc1 pd_68
    s_sub_u32 s11, s11, 1
    v_cmp_eq_u32 vcc, -1, v16
    s_cbranch_vccz ps_69
    s_add_u32 m0, s100, 45056
    s_add_u32 s12, s79, 0
    buffer_load_dwordx4 v1, s[44:47], s12 offen sc1 lds
ps_69:
    v_cmp_eq_u32 vcc, -1, v17
    s_cbranch_vccz ps_70
    s_add_u32 m0, s100, 46080
    s_add_u32 s12, s79, 1024
    buffer_load_dwordx4 v1, s[44:47], s12 offen sc1 lds
ps_70:
    v_cmp_eq_u32 vcc, -1, v18
    s_cbranch_vccz ps_71
    s_add_u32 m0, s100, 47104
    s_add_u32 s12, s79, 2048
    buffer_load_dwordx4 v1, s[44:47], s12 offen sc1 lds
ps_71:
    v_cmp_eq_u32 vcc, -1, v19
    s_cbranch_vccz ps_72
    s_add_u32 m0, s100, 48128
    s_add_u32 s12, s79, 3072
    buffer_load_dwordx4 v1, s[44:47], s12 offen sc1 lds
ps_72:
    s_waitcnt vmcnt(0)
    v_add_u32 v0, 45056, v9
    ds_read_b32 v16, v0 offset:0
    ds_read_b32 v17, v0 offset:1024
    ds_read_b32 v18, v0 offset:2048
    ds_read_b32 v19, v0 offset:3072
    s_waitcnt lgkmcnt(1)
    v_max3_u32 v8, v16, v17, v18
    s_waitcnt lgkmcnt(0)
    v_max_u32 v8, v8, v19
    v_cmp_eq_u32 vcc, -1, v8
    s_waitcnt lgkmcnt(0)
    s_cbranch_vccnz pc_67
    s_nop 4
pd_68:
    buffer_load_dwordx2 v[32:33], v44, s[44:47], s15 offen offset:0 sc1
    buffer_load_dwordx2 v[34:35], v44, s[44:47], s15 offen offset:512 sc1
    s_barrier
    v_add_u32 v6, 45056, v1
    ds_read_b128 v[120:123], v6 offset:0
    ds_read_b128 v[124:127], v6 offset:1024
    ds_read_b128 v[128:131], v6 offset:2048
    ds_read_b128 v[132:135], v6 offset:3072
    ds_read_b128 v[136:139], v6 offset:4096
    s_waitcnt lgkmcnt(4)
    v_mfma_f32_32x32x16_bf16 v[88:103], v[144:147], v[120:123], 0
    ds_read_b128 v[140:143], v6 offset:5120
    s_add_u32 m0, s100, 110592
    s_add_u32 s12, s79, 28672
    buffer_load_dwordx4 v1, s[44:47], s12 offen sc1 lds
    s_waitcnt lgkmcnt(4)
    v_mfma_f32_32x32x16_bf16 v[88:103], v[148:151], v[124:127], v[88:103]
    ds_read_b128 v[120:123], v6 offset:6144
    s_waitcnt lgkmcnt(4)
    v_mfma_f32_32x32x16_bf16 v[88:103], v[152:155], v[128:131], v[88:103]
    ds_read_b128 v[124:127], v6 offset:7168
    s_add_u32 m0, s100, 111616
    s_add_u32 s12, s79, 29696
    buffer_load_dwordx4 v1, s[44:47], s12 offen sc1 lds
    s_waitcnt lgkmcnt(4)
    v_mfma_f32_32x32x16_bf16 v[88:103], v[156:159], v[132:135], v[88:103]
    ds_read_b128 v[128:131], v6 offset:8192
    s_waitcnt lgkmcnt(4)
    v_mfma_f32_32x32x16_bf16 v[88:103], v[160:163], v[136:139], v[88:103]
    ds_read_b128 v[132:135], v6 offset:9216
    s_add_u32 m0, s100, 112640
    s_add_u32 s12, s79, 30720
    buffer_load_dwordx4 v1, s[44:47], s12 offen sc1 lds
    s_waitcnt lgkmcnt(4)
    v_mfma_f32_32x32x16_bf16 v[88:103], v[164:167], v[140:143], v[88:103]
    ds_read_b128 v[136:139], v6 offset:10240
    s_waitcnt lgkmcnt(4)
    v_mfma_f32_32x32x16_bf16 v[88:103], v[168:171], v[120:123], v[88:103]
    ds_read_b128 v[140:143], v6 offset:11264
    s_add_u32 m0, s100, 113664
    s_add_u32 s12, s79, 31744
    buffer_load_dwordx4 v1, s[44:47], s12 offen sc1 lds
    s_waitcnt lgkmcnt(4)
    v_mfma_f32_32x32x16_bf16 v[88:103], v[172:175], v[124:127], v[88:103]
    ds_read_b128 v[120:123], v6 offset:12288
    s_waitcnt lgkmcnt(4)
    v_mfma_f32_32x32x16_bf16 v[88:103], v[176:179], v[128:131], v[88:103]
    ds_read_b128 v[124:127], v6 offset:13312
    s_add_u32 m0, s100, 12288
    s_add_u32 s12, s79, 57344
    buffer_load_dwordx4 v1, s[44:47], s12 offen sc1 lds
    s_waitcnt lgkmcnt(4)
    v_mfma_f32_32x32x16_bf16 v[88:103], v[180:183], v[132:135], v[88:103]
    ds_read_b128 v[128:131], v6 offset:14336
    s_waitcnt lgkmcnt(4)
    v_mfma_f32_32x32x16_bf16 v[88:103], v[184:187], v[136:139], v[88:103]
    ds_read_b128 v[132:135], v6 offset:15360
    s_add_u32 m0, s100, 13312
    s_add_u32 s12, s79, 58368
    buffer_load_dwordx4 v1, s[44:47], s12 offen sc1 lds
    s_waitcnt lgkmcnt(4)
    v_mfma_f32_32x32x16_bf16 v[88:103], v[188:191], v[140:143], v[88:103]
    ds_read_b128 v[136:139], v6 offset:16384
    s_waitcnt lgkmcnt(4)
    v_mfma_f32_32x32x16_bf16 v[88:103], v[192:195], v[120:123], v[88:103]
    ds_read_b128 v[140:143], v6 offset:17408
    s_add_u32 m0, s100, 14336
    s_add_u32 s12, s79, 59392
    buffer_load_dwordx4 v1, s[44:47], s12 offen sc1 lds
    s_waitcnt lgkmcnt(4)
    v_mfma_f32_32x32x16_bf16 v[88:103], v[196:199], v[124:127], v[88:103]
    ds_read_b128 v[120:123], v6 offset:18432
    s_waitcnt lgkmcnt(4)
    v_mfma_f32_32x32x16_bf16 v[88:103], v[200:203], v[128:131], v[88:103]
    ds_read_b128 v[124:127], v6 offset:19456
    s_add_u32 m0, s100, 15360
    s_add_u32 s12, s79, 60416
    buffer_load_dwordx4 v1, s[44:47], s12 offen sc1 lds
    v_bfe_u32 v36, v1, 4, 2
    v_cmp_eq_u32_e64 s[20:21], 3, v36
    s_waitcnt vmcnt(8)
pc_73:
    s_nop 0
    v_cndmask_b32_e64 v34, v34, 0, s[20:21]
    v_max_u32 v37, v32, v34
    v_cmp_eq_u32 vcc, -1, v37
    s_cbranch_vccz pd_74
    s_cmp_eq_u32 s11, 0
    s_cbranch_scc1 pd_74
    s_sub_u32 s11, s11, 1
    buffer_load_dwordx2 v[32:33], v44, s[44:47], s15 offen offset:0 sc1
    buffer_load_dwordx2 v[34:35], v44, s[44:47], s15 offen offset:512 sc1
    s_waitcnt vmcnt(0)
    s_branch pc_73
pd_74:
    v_cndmask_b32_e64 v35, v35, 0, s[20:21]
    v_add_f32 v32, v32, v34
    v_add_f32 v33, v33, v35
    s_waitcnt lgkmcnt(4)
    v_mfma_f32_32x32x16_bf16 v[88:103], v[204:207], v[132:135], v[88:103]
    ds_read_b128 v[128:131], v6 offset:20480
    v_add_f32_dpp v32, v32, v32 quad_perm:[1,0,3,2] row_mask:0xf bank_mask:0xf
    v_add_f32_dpp v33, v33, v33 quad_perm:[1,0,3,2] row_mask:0xf bank_mask:0xf
    s_waitcnt lgkmcnt(4)
    v_mfma_f32_32x32x16_bf16 v[88:103], v[208:211], v[136:139], v[88:103]
    ds_read_b128 v[132:135], v6 offset:21504
    s_add_u32 m0, s100, 77824
    s_mul_i32 s12, s26, 28
    s_add_u32 s12, s12, s83
    buffer_load_dwordx4 v14, s[52:55], s12 offen lds
    v_add_f32_dpp v32, v32, v32 quad_perm:[2,3,0,1] row_mask:0xf bank_mask:0xf
    v_add_f32_dpp v33, v33, v33 quad_perm:[2,3,0,1] row_mask:0xf bank_mask:0xf
    s_waitcnt lgkmcnt(4)
    v_mfma_f32_32x32x16_bf16 v[88:103], v[212:215], v[140:143], v[88:103]
    ds_read_b128 v[136:139], v6 offset:22528
    v_mul_f32 v32, 0xbb124925, v32
    v_mul_f32 v33, 0x3b124925, v33
    v_fma_f32 v33, -v32, v32, v33
    v_max_f32 v33, 0, v33
    s_waitcnt lgkmcnt(4)
    v_mfma_f32_32x32x16_bf16 v[88:103], v[216:219], v[120:123], v[88:103]
    ds_read_b128 v[140:143], v6 offset:23552
    s_add_u32 m0, s100, 77824
    s_mul_i32 s12, s26, 28
    s_add_u32 s12, s12, s83
    s_add_u32 m0, m0, 1024
    s_add_u32 s12, s12, 7168
    buffer_load_dwordx4 v14, s[52:55], s12 offen lds
    v_add_f32 v33, 0x3727c5ac, v33
    v_and_b32 v43, 0xffffff7f, v33
    v_sqrt_f32 v33, v43
    v_lshrrev_b32 v39, 2, v1
    s_waitcnt lgkmcnt(4)
    v_mfma_f32_32x32x16_bf16 v[88:103], v[220:223], v[124:127], v[88:103]
    ds_read_b128 v[120:123], v6 offset:24576
    v_cvt_pk_bf16_f32 v34, v32, v33
    v_lshlrev_b32 v35, 16, v34
    v_and_b32 v36, 0xffff0000, v34
    v_sub_f32 v37, v32, v35
    s_waitcnt lgkmcnt(4)
    v_mfma_f32_32x32x16_bf16 v[88:103], v[224:227], v[128:131], v[88:103]
    ds_read_b128 v[124:127], v6 offset:25600
    s_add_u32 m0, s100, 77824
    s_mul_i32 s12, s26, 28
    s_add_u32 s12, s12, s83
    s_add_u32 m0, m0, 2048
    s_add_u32 s12, s12, 14336
    buffer_load_dwordx4 v14, s[52:55], s12 offen lds
    v_sub_f32 v38, v33, v36
    v_cvt_pk_bf16_f32 v37, v37, v38
    v_perm_b32 v40, v34, v34, s38
    v_and_b32 v41, 0xffff, v37
    s_waitcnt lgkmcnt(4)
    v_mfma_f32_32x32x16_bf16 v[88:103], v[228:231], v[132:135], v[88:103]
    ds_read_b128 v[128:131], v6 offset:26624
    v_or_b32 v41, v41, v36
    v_perm_b32 v42, v37, v34, s39
    s_lshl_b32 s12, s3, 8
    v_and_b32 v39, 0xf0, v39
    v_add_u32 v39, s12, v39
    ds_write_b128 v39, v[40:43] offset:0
    s_waitcnt lgkmcnt(5)
    v_mfma_f32_32x32x16_bf16 v[88:103], v[232:235], v[136:139], v[88:103]
    ds_read_b128 v[132:135], v6 offset:27648
    s_add_u32 m0, s100, 77824
    s_mul_i32 s12, s26, 28
    s_add_u32 s12, s12, s83
    s_add_u32 m0, m0, 3072
    s_add_u32 s12, s12, 21504
    buffer_load_dwordx4 v14, s[52:55], s12 offen lds
    s_waitcnt vmcnt(8)
    v_add_u32 v0, 110592, v9
    ds_read_b32 v2, v0 offset:0
    ds_read_b32 v11, v0 offset:1024
    ds_read_b32 v12, v0 offset:2048
    ds_read_b32 v13, v0 offset:3072
    s_waitcnt lgkmcnt(1)
    v_max3_u32 v8, v2, v11, v12
    s_waitcnt lgkmcnt(0)
    v_max_u32 v8, v8, v13
    v_cmp_eq_u32 vcc, -1, v8
    s_cbranch_vccz pd_76
pc_75:
    s_cmp_eq_u32 s11, 0
    s_cbranch_scc1 pd_76
    s_sub_u32 s11, s11, 1
    v_cmp_eq_u32 vcc, -1, v2
    s_cbranch_vccz ps_77
    s_add_u32 m0, s100, 110592
    s_add_u32 s12, s79, 28672
    buffer_load_dwordx4 v1, s[44:47], s12 offen sc1 lds
ps_77:
    v_cmp_eq_u32 vcc, -1, v11
    s_cbranch_vccz ps_78
    s_add_u32 m0, s100, 111616
    s_add_u32 s12, s79, 29696
    buffer_load_dwordx4 v1, s[44:47], s12 offen sc1 lds
ps_78:
    v_cmp_eq_u32 vcc, -1, v12
    s_cbranch_vccz ps_79
    s_add_u32 m0, s100, 112640
    s_add_u32 s12, s79, 30720
    buffer_load_dwordx4 v1, s[44:47], s12 offen sc1 lds
ps_79:
    v_cmp_eq_u32 vcc, -1, v13
    s_cbranch_vccz ps_80
    s_add_u32 m0, s100, 113664
    s_add_u32 s12, s79, 31744
    buffer_load_dwordx4 v1, s[44:47], s12 offen sc1 lds
ps_80:
    s_waitcnt vmcnt(0)
    v_add_u32 v0, 110592, v9
    ds_read_b32 v2, v0 offset:0
    ds_read_b32 v11, v0 offset:1024
    ds_read_b32 v12, v0 offset:2048
    ds_read_b32 v13, v0 offset:3072
    s_waitcnt lgkmcnt(1)
    v_max3_u32 v8, v2, v11, v12
    s_waitcnt lgkmcnt(0)
    v_max_u32 v8, v8, v13
    v_cmp_eq_u32 vcc, -1, v8
    s_waitcnt lgkmcnt(0)
    s_cbranch_vccnz pc_75
    s_nop 4
pd_76:
    v_mfma_f32_32x32x16_bf16 v[88:103], v[236:239], v[140:143], v[88:103]
    v_mfma_f32_32x32x16_bf16 v[88:103], v[240:243], v[120:123], v[88:103]
    s_barrier
    s_setprio 0
    s_cmp_lt_u32 s3, 4
    s_cbranch_scc1 pr_81
    s_setprio 1
pr_81:
    v_add_u32 v6, 110592, v1
    ds_read_b128 v[136:139], v6 offset:0
    ds_read_b128 v[140:143], v6 offset:1024
    v_and_b32 v8, 0x1f0, v1
    ds_read_b128 v[68:71], v8 offset:0
    v_mfma_f32_32x32x16_bf16 v[88:103], v[244:247], v[124:127], v[88:103]
    ds_read_b128 v[120:123], v6 offset:2048
    s_add_u32 m0, s100, 45056
    s_mul_i32 s12, s27, 28
    s_add_u32 s12, s12, s83
    buffer_load_dwordx4 v14, s[52:55], s12 offen lds
    v_mfma_f32_32x32x16_bf16 v[88:103], v[248:251], v[128:131], v[88:103]
    ds_read_b128 v[124:127], v6 offset:3072
    s_add_u32 m0, s100, 45056
    s_mul_i32 s12, s27, 28
    s_add_u32 s12, s12, s83
    s_add_u32 m0, m0, 1024
    s_add_u32 s12, s12, 7168
    buffer_load_dwordx4 v14, s[52:55], s12 offen lds
    v_mfma_f32_32x32x16_bf16 v[88:103], v[252:255], v[132:135], v[88:103]
    ds_read_b128 v[128:131], v6 offset:4096
    s_add_u32 m0, s100, 45056
    s_mul_i32 s12, s27, 28
    s_add_u32 s12, s12, s83
    s_add_u32 m0, m0, 2048
    s_add_u32 s12, s12, 14336
    buffer_load_dwordx4 v14, s[52:55], s12 offen lds
    s_waitcnt lgkmcnt(3)
    v_mfma_f32_32x32x16_bf16 v[88:103], v[52:55], v[68:71], v[88:103]
    v_mfma_f32_32x32x16_bf16 v[104:119], v[144:147], v[136:139], 0
    ds_read_b128 v[132:135], v6 offset:5120
    s_add_u32 m0, s100, 45056
    s_mul_i32 s12, s27, 28
    s_add_u32 s12, s12, s83
    s_add_u32 m0, m0, 3072
    s_add_u32 s12, s12, 21504
    buffer_load_dwordx4 v14, s[52:55], s12 offen lds
    v_rsq_f32 v5, v71
    v_mfma_f32_32x32x16_bf16 v[104:119], v[148:151], v[140:143], v[104:119]
    ds_read_b128 v[136:139], v6 offset:6144
    v_mul_f32 v4, 0xc0135761, v5
    v_mul_f32 v56, v5, v5
    v_mul_f32 v5, v5, v56
    v_mul_f32 v5, 0xbdd2d3e8, v5
    s_waitcnt lgkmcnt(4)
    v_mfma_f32_32x32x16_bf16 v[104:119], v[152:155], v[120:123], v[104:119]
    ds_read_b128 v[140:143], v6 offset:7168
    s_waitcnt lgkmcnt(4)
    v_mfma_f32_32x32x16_bf16 v[104:119], v[156:159], v[124:127], v[104:119]
    ds_read_b128 v[120:123], v6 offset:8192
    v_mul_f32 v56, v88, v88
    v_mul_f32 v57, v89, v89
    v_mul_f32 v58, v90, v90
    v_mul_f32 v59, v91, v91
    s_waitcnt lgkmcnt(4)
    v_mfma_f32_32x32x16_bf16 v[104:119], v[160:163], v[128:131], v[104:119]
    ds_read_b128 v[124:127], v6 offset:9216
    v_fma_f32 v56, v56, v5, v4
    v_fma_f32 v57, v57, v5, v4
    v_fma_f32 v58, v58, v5, v4
    v_fma_f32 v59, v59, v5, v4
    s_waitcnt lgkmcnt(4)
    v_mfma_f32_32x32x16_bf16 v[104:119], v[164:167], v[132:135], v[104:119]
    ds_read_b128 v[128:131], v6 offset:10240
    v_mul_f32 v56, v56, v88
    v_mul_f32 v57, v57, v89
    v_mul_f32 v58, v58, v90
    v_mul_f32 v59, v59, v91
    s_waitcnt lgkmcnt(4)
    v_mfma_f32_32x32x16_bf16 v[104:119], v[168:171], v[136:139], v[104:119]
    ds_read_b128 v[132:135], v6 offset:11264
    v_mul_f32 v60, v92, v92
    v_mul_f32 v61, v93, v93
    v_mul_f32 v62, v94, v94
    v_mul_f32 v63, v95, v95
    s_waitcnt lgkmcnt(4)
    v_mfma_f32_32x32x16_bf16 v[104:119], v[172:175], v[140:143], v[104:119]
    ds_read_b128 v[136:139], v6 offset:12288
    v_fma_f32 v60, v60, v5, v4
    v_fma_f32 v61, v61, v5, v4
    v_fma_f32 v62, v62, v5, v4
    v_fma_f32 v63, v63, v5, v4
    s_waitcnt lgkmcnt(4)
    v_mfma_f32_32x32x16_bf16 v[104:119], v[176:179], v[120:123], v[104:119]
    ds_read_b128 v[140:143], v6 offset:13312
    v_mul_f32 v60, v60, v92
    v_mul_f32 v61, v61, v93
    v_mul_f32 v62, v62, v94
    v_mul_f32 v63, v63, v95
    s_waitcnt vmcnt(4)
    s_add_u32 s13, s100, 77824
    v_add_u32 v8, s13, v10
    ds_read_b64_tr_b16 v[16:17], v8 offset:0
    ds_read_b64_tr_b16 v[18:19], v8 offset:1024
    v_add_u32 v8, s13, v10
    v_xor_b32 v8, 32, v8
    ds_read_b64_tr_b16 v[20:21], v8 offset:0
    ds_read_b64_tr_b16 v[22:23], v8 offset:1024
    s_waitcnt lgkmcnt(8)
    v_mfma_f32_32x32x16_bf16 v[104:119], v[180:183], v[124:127], v[104:119]
    ds_read_b128 v[120:123], v6 offset:14336
    v_exp_f32 v56, v56
    v_mul_f32 v96, v96, v88
    v_exp_f32 v57, v57
    v_mul_f32 v97, v97, v89
    s_add_u32 s13, s100, 77824
    v_add_u32 v8, s13, v10
    v_xor_b32 v8, 64, v8
    ds_read_b64_tr_b16 v[24:25], v8 offset:0
    ds_read_b64_tr_b16 v[26:27], v8 offset:1024
    v_add_u32 v8, s13, v10
    v_xor_b32 v8, 96, v8
    ds_read_b64_tr_b16 v[28:29], v8 offset:0
    ds_read_b64_tr_b16 v[30:31], v8 offset:1024
    s_waitcnt lgkmcnt(12)
    v_mfma_f32_32x32x16_bf16 v[104:119], v[184:187], v[128:131], v[104:119]
    ds_read_b128 v[124:127], v6 offset:15360
    v_exp_f32 v58, v58
    v_mul_f32 v98, v98, v90
    v_exp_f32 v59, v59
    v_mul_f32 v99, v99, v91
    s_setprio 0
    s_waitcnt lgkmcnt(12)
    v_mfma_f32_32x32x16_bf16 v[104:119], v[188:191], v[132:135], v[104:119]
    ds_read_b128 v[128:131], v6 offset:16384
    v_exp_f32 v60, v60
    v_mul_f32 v100, v100, v92
    v_exp_f32 v61, v61
    v_mul_f32 v101, v101, v93
    s_waitcnt lgkmcnt(2)
    s_add_u32 m0, s100, 77824
    s_mul_i32 s12, s28, 28
    s_add_u32 s12, s12, s83
    buffer_load_dwordx4 v14, s[52:55], s12 offen lds
    v_mfma_f32_32x32x16_bf16 v[104:119], v[192:195], v[136:139], v[104:119]
    ds_read_b128 v[132:135], v6 offset:17408
    v_exp_f32 v62, v62
    v_mul_f32 v102, v102, v94
    v_exp_f32 v63, v63
    v_mul_f32 v103, v103, v95
    s_add_u32 m0, s100, 77824
    s_mul_i32 s12, s28, 28
    s_add_u32 s12, s12, s83
    s_add_u32 m0, m0, 1024
    s_add_u32 s12, s12, 7168
    buffer_load_dwordx4 v14, s[52:55], s12 offen lds
    v_mfma_f32_32x32x16_bf16 v[104:119], v[196:199], v[140:143], v[104:119]
    ds_read_b128 v[136:139], v6 offset:18432
    v_fma_f32 v56, v56, v71, v71
    v_fma_f32 v57, v57, v71, v71
    v_rcp_f32 v56, v56
    v_rcp_f32 v57, v57
    s_add_u32 m0, s100, 77824
    s_mul_i32 s12, s28, 28
    s_add_u32 s12, s12, s83
    s_add_u32 m0, m0, 2048
    s_add_u32 s12, s12, 14336
    buffer_load_dwordx4 v14, s[52:55], s12 offen lds
    v_mfma_f32_32x32x16_bf16 v[104:119], v[200:203], v[120:123], v[104:119]
    ds_read_b128 v[140:143], v6 offset:19456
    v_fma_f32 v58, v58, v71, v71
    v_fma_f32 v59, v59, v71, v71
    v_rcp_f32 v58, v58
    v_rcp_f32 v59, v59
    s_add_u32 m0, s100, 77824
    s_mul_i32 s12, s28, 28
    s_add_u32 s12, s12, s83
    s_add_u32 m0, m0, 3072
    s_add_u32 s12, s12, 21504
    buffer_load_dwordx4 v14, s[52:55], s12 offen lds
    s_waitcnt lgkmcnt(4)
    v_mfma_f32_32x32x16_bf16 v[104:119], v[204:207], v[124:127], v[104:119]
    ds_read_b128 v[120:123], v6 offset:20480
    v_fma_f32 v60, v60, v71, v71
    v_fma_f32 v61, v61, v71, v71
    v_rcp_f32 v60, v60
    v_rcp_f32 v61, v61
    s_add_u32 m0, s82, 0
    s_add_u32 s12, s79, 86016
    buffer_load_dwordx4 v1, s[44:47], s12 offen sc1 lds
    s_waitcnt lgkmcnt(4)
    v_mfma_f32_32x32x16_bf16 v[104:119], v[208:211], v[128:131], v[104:119]
    ds_read_b128 v[124:127], v6 offset:21504
    v_fma_f32 v62, v62, v71, v71
    v_fma_f32 v63, v63, v71, v71
    v_rcp_f32 v62, v62
    v_rcp_f32 v63, v63
    s_waitcnt lgkmcnt(4)
    v_mfma_f32_32x32x16_bf16 v[104:119], v[212:215], v[132:135], v[104:119]
    ds_read_b128 v[128:131], v6 offset:22528
    v_mul_f32 v56, v56, v96
    v_mul_f32 v57, v57, v97
    v_mul_f32 v58, v58, v98
    v_mul_f32 v59, v59, v99
    s_add_u32 m0, s82, 1024
    s_add_u32 s12, s79, 87040
    buffer_load_dwordx4 v1, s[44:47], s12 offen sc1 lds
    s_waitcnt lgkmcnt(4)
    v_mfma_f32_32x32x16_bf16 v[104:119], v[216:219], v[136:139], v[104:119]
    ds_read_b128 v[132:135], v6 offset:23552
    v_mul_f32 v60, v60, v100
    v_mul_f32 v61, v61, v101
    v_mul_f32 v62, v62, v102
    v_mul_f32 v63, v63, v103
    s_waitcnt lgkmcnt(4)
    v_mfma_f32_32x32x16_bf16 v[104:119], v[220:223], v[140:143], v[104:119]
    ds_read_b128 v[136:139], v6 offset:24576
    v_cvt_pk_bf16_f32 v56, v56, v57
    v_cvt_pk_bf16_f32 v57, v58, v59
    v_cvt_pk_bf16_f32 v58, v60, v61
    v_cvt_pk_bf16_f32 v59, v62, v63
    buffer_store_dwordx4 v[56:59], v7, s[44:47], s43 offen sc1
    s_add_u32 m0, s82, 2048
    s_add_u32 s12, s79, 88064
    buffer_load_dwordx4 v1, s[44:47], s12 offen sc1 lds
    s_waitcnt lgkmcnt(4)
    v_mfma_f32_32x32x16_bf16 v[104:119], v[224:227], v[120:123], v[104:119]
    ds_read_b128 v[140:143], v6 offset:25600
    s_waitcnt lgkmcnt(4)
    v_mfma_f32_32x32x16_bf16 v[104:119], v[228:231], v[124:127], v[104:119]
    ds_read_b128 v[120:123], v6 offset:26624
    s_add_u32 m0, s82, 3072
    s_add_u32 s12, s79, 89088
    buffer_load_dwordx4 v1, s[44:47], s12 offen sc1 lds
    s_waitcnt lgkmcnt(4)
    v_mfma_f32_32x32x16_bf16 v[104:119], v[232:235], v[128:131], v[104:119]
    ds_read_b128 v[124:127], v6 offset:27648
    s_waitcnt lgkmcnt(4)
    v_mfma_f32_32x32x16_bf16 v[104:119], v[236:239], v[132:135], v[104:119]
    s_waitcnt lgkmcnt(3)
    v_mfma_f32_32x32x16_bf16 v[104:119], v[240:243], v[136:139], v[104:119]
    v_add_u32 v0, 12288, v9
    ds_read_b32 v2, v0 offset:0
    ds_read_b32 v11, v0 offset:1024
    ds_read_b32 v12, v0 offset:2048
    ds_read_b32 v13, v0 offset:3072
    s_waitcnt lgkmcnt(1)
    v_max3_u32 v8, v2, v11, v12
    s_waitcnt lgkmcnt(0)
    v_max_u32 v8, v8, v13
    v_cmp_eq_u32 vcc, -1, v8
    s_cbranch_vccz pd_83
pc_82:
    s_cmp_eq_u32 s11, 0
    s_cbranch_scc1 pd_83
    s_sub_u32 s11, s11, 1
    v_cmp_eq_u32 vcc, -1, v2
    s_cbranch_vccz ps_84
    s_add_u32 m0, s100, 12288
    s_add_u32 s12, s79, 57344
    buffer_load_dwordx4 v1, s[44:47], s12 offen sc1 lds
ps_84:
    v_cmp_eq_u32 vcc, -1, v11
    s_cbranch_vccz ps_85
    s_add_u32 m0, s100, 13312
    s_add_u32 s12, s79, 58368
    buffer_load_dwordx4 v1, s[44:47], s12 offen sc1 lds
ps_85:
    v_cmp_eq_u32 vcc, -1, v12
    s_cbranch_vccz ps_86
    s_add_u32 m0, s100, 14336
    s_add_u32 s12, s79, 59392
    buffer_load_dwordx4 v1, s[44:47], s12 offen sc1 lds
ps_86:
    v_cmp_eq_u32 vcc, -1, v13
    s_cbranch_vccz ps_87
    s_add_u32 m0, s100, 15360
    s_add_u32 s12, s79, 60416
    buffer_load_dwordx4 v1, s[44:47], s12 offen sc1 lds
ps_87:
    s_waitcnt vmcnt(0)
    v_add_u32 v0, 12288, v9
    ds_read_b32 v2, v0 offset:0
    ds_read_b32 v11, v0 offset:1024
    ds_read_b32 v12, v0 offset:2048
    ds_read_b32 v13, v0 offset:3072
    s_waitcnt lgkmcnt(1)
    v_max3_u32 v8, v2, v11, v12
    s_waitcnt lgkmcnt(0)
    v_max_u32 v8, v8, v13
    v_cmp_eq_u32 vcc, -1, v8
    s_waitcnt lgkmcnt(0)
    s_cbranch_vccnz pc_82
    s_nop 4
pd_83:
    s_barrier
    s_setprio 0
    s_cmp_lt_u32 s3, 4
    s_cbranch_scc1 pr_88
    s_setprio 1
pr_88:
    v_add_u32 v6, 12288, v1
    ds_read_b128 v[128:131], v6 offset:0
    ds_read_b128 v[132:135], v6 offset:1024
    v_and_b32 v8, 0x1f0, v1
    ds_read_b128 v[68:71], v8 offset:512
    v_mfma_f32_32x32x16_bf16 v[104:119], v[244:247], v[140:143], v[104:119]
    ds_read_b128 v[136:139], v6 offset:2048
    s_add_u32 m0, s100, 110592
    s_mul_i32 s12, s29, 28
    s_add_u32 s12, s12, s83
    buffer_load_dwordx4 v14, s[52:55], s12 offen lds
    v_mfma_f32_32x32x16_bf16 v[104:119], v[248:251], v[120:123], v[104:119]
    ds_read_b128 v[140:143], v6 offset:3072
    s_add_u32 m0, s100, 110592
    s_mul_i32 s12, s29, 28
    s_add_u32 s12, s12, s83
    s_add_u32 m0, m0, 1024
    s_add_u32 s12, s12, 7168
    buffer_load_dwordx4 v14, s[52:55], s12 offen lds
    v_mfma_f32_32x32x16_bf16 v[104:119], v[252:255], v[124:127], v[104:119]
    ds_read_b128 v[120:123], v6 offset:4096
    s_add_u32 m0, s100, 110592
    s_mul_i32 s12, s29, 28
    s_add_u32 s12, s12, s83
    s_add_u32 m0, m0, 2048
    s_add_u32 s12, s12, 14336
    buffer_load_dwordx4 v14, s[52:55], s12 offen lds
    s_waitcnt lgkmcnt(3)
    v_mfma_f32_32x32x16_bf16 v[104:119], v[52:55], v[68:71], v[104:119]
    v_mfma_f32_32x32x16_bf16 v[88:103], v[144:147], v[128:131], 0
    ds_read_b128 v[124:127], v6 offset:5120
    s_add_u32 m0, s100, 110592
    s_mul_i32 s12, s29, 28
    s_add_u32 s12, s12, s83
    s_add_u32 m0, m0, 3072
    s_add_u32 s12, s12, 21504
    buffer_load_dwordx4 v14, s[52:55], s12 offen lds
    v_rsq_f32 v5, v71
    v_mfma_f32_32x32x16_bf16 v[88:103], v[148:151], v[132:135], v[88:103]
    ds_read_b128 v[128:131], v6 offset:6144
    v_mul_f32 v4, 0xc0135761, v5
    v_mul_f32 v56, v5, v5
    v_mul_f32 v5, v5, v56
    v_mul_f32 v5, 0xbdd2d3e8, v5
    s_waitcnt lgkmcnt(4)
    v_mfma_f32_32x32x16_bf16 v[88:103], v[152:155], v[136:139], v[88:103]
    ds_read_b128 v[132:135], v6 offset:7168
    s_waitcnt vmcnt(13)
    s_add_u32 s13, s100, 45056
    v_add_u32 v8, s13, v10
    ds_read_b64_tr_b16 v[32:33], v8 offset:0
    ds_read_b64_tr_b16 v[34:35], v8 offset:1024
    v_add_u32 v8, s13, v10
    v_xor_b32 v8, 32, v8
    ds_read_b64_tr_b16 v[36:37], v8 offset:0
    ds_read_b64_tr_b16 v[38:39], v8 offset:1024
    s_waitcnt lgkmcnt(8)
    v_mfma_f32_32x32x16_bf16 v[88:103], v[156:159], v[140:143], v[88:103]
    ds_read_b128 v[136:139], v6 offset:8192
    v_mul_f32 v56, v104, v104
    v_mul_f32 v57, v105, v105
    v_mul_f32 v58, v106, v106
    v_mul_f32 v59, v107, v107
    s_add_u32 s13, s100, 45056
    v_add_u32 v8, s13, v10
    v_xor_b32 v8, 64, v8
    ds_read_b64_tr_b16 v[40:41], v8 offset:0
    ds_read_b64_tr_b16 v[42:43], v8 offset:1024
    v_add_u32 v8, s13, v10
    v_xor_b32 v8, 96, v8
    ds_read_b64_tr_b16 v[44:45], v8 offset:0
    ds_read_b64_tr_b16 v[46:47], v8 offset:1024
    s_waitcnt lgkmcnt(12)
    v_mfma_f32_32x32x16_bf16 v[88:103], v[160:163], v[120:123], v[88:103]
    ds_read_b128 v[140:143], v6 offset:9216
    v_fma_f32 v56, v56, v5, v4
    v_fma_f32 v57, v57, v5, v4
    v_fma_f32 v58, v58, v5, v4
    v_fma_f32 v59, v59, v5, v4
    s_waitcnt lgkmcnt(12)
    v_mfma_f32_32x32x16_bf16 v[88:103], v[164:167], v[124:127], v[88:103]
    ds_read_b128 v[120:123], v6 offset:10240
    v_mul_f32 v56, v56, v104
    v_mul_f32 v57, v57, v105
    v_mul_f32 v58, v58, v106
    v_mul_f32 v59, v59, v107
    s_waitcnt lgkmcnt(2)
    s_add_u32 m0, s100, 45056
    s_mul_i32 s12, s30, 28
    s_add_u32 s12, s12, s83
    buffer_load_dwordx4 v14, s[52:55], s12 offen lds
    v_mfma_f32_32x32x16_bf16 v[88:103], v[168:171], v[128:131], v[88:103]
    ds_read_b128 v[124:127], v6 offset:11264
    v_mul_f32 v60, v108, v108
    v_mul_f32 v61, v109, v109
    v_mul_f32 v62, v110, v110
    v_mul_f32 v63, v111, v111
    s_add_u32 m0, s100, 45056
    s_mul_i32 s12, s30, 28
    s_add_u32 s12, s12, s83
    s_add_u32 m0, m0, 1024
    s_add_u32 s12, s12, 7168
    buffer_load_dwordx4 v14, s[52:55], s12 offen lds
    v_mfma_f32_32x32x16_bf16 v[88:103], v[172:175], v[132:135], v[88:103]
    ds_read_b128 v[128:131], v6 offset:12288
    v_fma_f32 v60, v60, v5, v4
    v_fma_f32 v61, v61, v5, v4
    v_fma_f32 v62, v62, v5, v4
    v_fma_f32 v63, v63, v5, v4
    s_add_u32 m0, s100, 45056
    s_mul_i32 s12, s30, 28
    s_add_u32 s12, s12, s83
    s_add_u32 m0, m0, 2048
    s_add_u32 s12, s12, 14336
    buffer_load_dwordx4 v14, s[52:55], s12 offen lds
    v_mfma_f32_32x32x16_bf16 v[88:103], v[176:179], v[136:139], v[88:103]
    ds_read_b128 v[132:135], v6 offset:13312
    v_mul_f32 v60, v60, v108
    v_mul_f32 v61, v61, v109
    v_mul_f32 v62, v62, v110
    v_mul_f32 v63, v63, v111
    s_add_u32 m0, s100, 45056
    s_mul_i32 s12, s30, 28
    s_add_u32 s12, s12, s83
    s_add_u32 m0, m0, 3072
    s_add_u32 s12, s12, 21504
    buffer_load_dwordx4 v14, s[52:55], s12 offen lds
    s_waitcnt lgkmcnt(4)
    v_mfma_f32_32x32x16_bf16 v[88:103], v[180:183], v[140:143], v[88:103]
    ds_read_b128 v[136:139], v6 offset:14336
    v_exp_f32 v56, v56
    v_mul_f32 v112, v112, v104
    v_exp_f32 v57, v57
    v_mul_f32 v113, v113, v105
    s_waitcnt lgkmcnt(4)
    v_mfma_f32_32x32x16_bf16 v[88:103], v[184:187], v[120:123], v[88:103]
    ds_read_b128 v[140:143], v6 offset:15360
    v_exp_f32 v58, v58
    v_mul_f32 v114, v114, v106
    v_exp_f32 v59, v59
    v_mul_f32 v115, v115, v107
    s_setprio 0
    s_waitcnt lgkmcnt(4)
    v_mfma_f32_32x32x16_bf16 v[88:103], v[188:191], v[124:127], v[88:103]
    ds_read_b128 v[120:123], v6 offset:16384
    v_exp_f32 v60, v60
    v_mul_f32 v116, v116, v108
    v_exp_f32 v61, v61
    v_mul_f32 v117, v117, v109
    s_waitcnt lgkmcnt(4)
    v_mfma_f32_32x32x16_bf16 v[88:103], v[192:195], v[128:131], v[88:103]
    ds_read_b128 v[124:127], v6 offset:17408
    v_exp_f32 v62, v62
    v_mul_f32 v118, v118, v110
    v_exp_f32 v63, v63
    v_mul_f32 v119, v119, v111
    s_waitcnt vmcnt(13)
    s_add_u32 s13, s100, 77824
    v_add_u32 v8, s13, v10
    ds_read_b64_tr_b16 v[72:73], v8 offset:0
    ds_read_b64_tr_b16 v[74:75], v8 offset:1024
    v_add_u32 v8, s13, v10
    v_xor_b32 v8, 32, v8
    ds_read_b64_tr_b16 v[76:77], v8 offset:0
    ds_read_b64_tr_b16 v[78:79], v8 offset:1024
    s_waitcnt lgkmcnt(8)
    v_mfma_f32_32x32x16_bf16 v[88:103], v[196:199], v[132:135], v[88:103]
    ds_read_b128 v[128:131], v6 offset:18432
    v_fma_f32 v56, v56, v71, v71
    v_fma_f32 v57, v57, v71, v71
    v_rcp_f32 v56, v56
    v_rcp_f32 v57, v57
    s_add_u32 s13, s100, 77824
    v_add_u32 v8, s13, v10
    v_xor_b32 v8, 64, v8
    ds_read_b64_tr_b16 v[80:81], v8 offset:0
    ds_read_b64_tr_b16 v[82:83], v8 offset:1024
    v_add_u32 v8, s13, v10
    v_xor_b32 v8, 96, v8
    ds_read_b64_tr_b16 v[84:85], v8 offset:0
    ds_read_b64_tr_b16 v[86:87], v8 offset:1024
    s_waitcnt lgkmcnt(12)
    v_mfma_f32_32x32x16_bf16 v[88:103], v[200:203], v[136:139], v[88:103]
    ds_read_b128 v[132:135], v6 offset:19456
    v_fma_f32 v58, v58, v71, v71
    v_fma_f32 v59, v59, v71, v71
    v_rcp_f32 v58, v58
    v_rcp_f32 v59, v59
    s_waitcnt lgkmcnt(12)
    v_mfma_f32_32x32x16_bf16 v[88:103], v[204:207], v[140:143], v[88:103]
    ds_read_b128 v[136:139], v6 offset:20480
    v_fma_f32 v60, v60, v71, v71
    v_fma_f32 v61, v61, v71, v71
    v_rcp_f32 v60, v60
    v_rcp_f32 v61, v61
    s_waitcnt lgkmcnt(2)
    s_add_u32 m0, s100, 77824
    s_mul_i32 s12, s32, 28
    s_add_u32 s12, s12, s83
    buffer_load_dwordx4 v14, s[52:55], s12 offen lds
    v_mfma_f32_32x32x16_bf16 v[88:103], v[208:211], v[120:123], v[88:103]
    ds_read_b128 v[140:143], v6 offset:21504
    v_fma_f32 v62, v62, v71, v71
    v_fma_f32 v63, v63, v71, v71
    v_rcp_f32 v62, v62
    v_rcp_f32 v63, v63
    s_add_u32 m0, s100, 77824
    s_mul_i32 s12, s32, 28
    s_add_u32 s12, s12, s83
    s_add_u32 m0, m0, 1024
    s_add_u32 s12, s12, 7168
    buffer_load_dwordx4 v14, s[52:55], s12 offen lds
    v_mfma_f32_32x32x16_bf16 v[88:103], v[212:215], v[124:127], v[88:103]
    ds_read_b128 v[120:123], v6 offset:22528
    v_mul_f32 v56, v56, v112
    v_mul_f32 v57, v57, v113
    v_mul_f32 v58, v58, v114
    v_mul_f32 v59, v59, v115
    s_add_u32 m0, s100, 77824
    s_mul_i32 s12, s32, 28
    s_add_u32 s12, s12, s83
    s_add_u32 m0, m0, 2048
    s_add_u32 s12, s12, 14336
    buffer_load_dwordx4 v14, s[52:55], s12 offen lds
    v_mfma_f32_32x32x16_bf16 v[88:103], v[216:219], v[128:131], v[88:103]
    ds_read_b128 v[124:127], v6 offset:23552
    v_mul_f32 v60, v60, v116
    v_mul_f32 v61, v61, v117
    v_mul_f32 v62, v62, v118
    v_mul_f32 v63, v63, v119
    s_add_u32 m0, s100, 77824
    s_mul_i32 s12, s32, 28
    s_add_u32 s12, s12, s83
    s_add_u32 m0, m0, 3072
    s_add_u32 s12, s12, 21504
    buffer_load_dwordx4 v14, s[52:55], s12 offen lds
    s_waitcnt lgkmcnt(4)
    v_mfma_f32_32x32x16_bf16 v[88:103], v[220:223], v[132:135], v[88:103]
    ds_read_b128 v[128:131], v6 offset:24576
    v_cvt_pk_bf16_f32 v56, v56, v57
    v_cvt_pk_bf16_f32 v57, v58, v59
    v_cvt_pk_bf16_f32 v58, v60, v61
    v_cvt_pk_bf16_f32 v59, v62, v63
    s_add_u32 s43, s43, 114688
    buffer_store_dwordx4 v[56:59], v7, s[44:47], s43 offen sc1
    s_waitcnt lgkmcnt(4)
    v_mfma_f32_32x32x16_bf16 v[88:103], v[224:227], v[136:139], v[88:103]
    ds_read_b128 v[132:135], v6 offset:25600
    s_waitcnt lgkmcnt(4)
    v_mfma_f32_32x32x16_bf16 v[88:103], v[228:231], v[140:143], v[88:103]
    ds_read_b128 v[136:139], v6 offset:26624
    s_waitcnt vmcnt(13)
    v_add_u32 v0, s82, v1
    ds_read_b32 v2, v0 offset:0
    ds_read_b32 v11, v0 offset:1024
    ds_read_b32 v12, v0 offset:2048
    ds_read_b32 v13, v0 offset:3072
    s_waitcnt lgkmcnt(1)
    v_max3_u32 v8, v2, v11, v12
    s_waitcnt lgkmcnt(0)
    v_max_u32 v8, v8, v13
    v_cmp_eq_u32 vcc, -1, v8
    s_cbranch_vccz pd_90
pc_89:
    s_cmp_eq_u32 s11, 0
    s_cbranch_scc1 pd_90
    s_sub_u32 s11, s11, 1
    v_cmp_eq_u32 vcc, -1, v2
    s_cbranch_vccz ps_91
    s_add_u32 m0, s82, 0
    s_add_u32 s12, s79, 86016
    buffer_load_dwordx4 v1, s[44:47], s12 offen sc1 lds
ps_91:
    v_cmp_eq_u32 vcc, -1, v11
    s_cbranch_vccz ps_92
    s_add_u32 m0, s82, 1024
    s_add_u32 s12, s79, 87040
    buffer_load_dwordx4 v1, s[44:47], s12 offen sc1 lds
ps_92:
    v_cmp_eq_u32 vcc, -1, v12
    s_cbranch_vccz ps_93
    s_add_u32 m0, s82, 2048
    s_add_u32 s12, s79, 88064
    buffer_load_dwordx4 v1, s[44:47], s12 offen sc1 lds
ps_93:
    v_cmp_eq_u32 vcc, -1, v13
    s_cbranch_vccz ps_94
    s_add_u32 m0, s82, 3072
    s_add_u32 s12, s79, 89088
    buffer_load_dwordx4 v1, s[44:47], s12 offen sc1 lds
ps_94:
    s_waitcnt vmcnt(0)
    v_add_u32 v0, s82, v1
    ds_read_b32 v2, v0 offset:0
    ds_read_b32 v11, v0 offset:1024
    ds_read_b32 v12, v0 offset:2048
    ds_read_b32 v13, v0 offset:3072
    s_waitcnt lgkmcnt(1)
    v_max3_u32 v8, v2, v11, v12
    s_waitcnt lgkmcnt(0)
    v_max_u32 v8, v8, v13
    v_cmp_eq_u32 vcc, -1, v8
    s_waitcnt lgkmcnt(0)
    s_cbranch_vccnz pc_89
    s_nop 4
pd_90:
    v_mfma_f32_32x32x16_bf16 v[88:103], v[232:235], v[120:123], v[88:103]
    ds_read_b128 v[140:143], v6 offset:27648
    v_mfma_f32_32x32x16_bf16 v[88:103], v[236:239], v[124:127], v[88:103]
    v_mfma_f32_32x32x16_bf16 v[88:103], v[240:243], v[128:131], v[88:103]
    s_waitcnt lgkmcnt(0)
    s_barrier
    s_setprio 2
    s_cmp_lt_u32 s3, 4
    s_cbranch_scc1 pr_95
    s_setprio 3
pr_95:
    v_add_u32 v6, 4096, v1
    ds_read_b128 v[120:123], v6 offset:0
    ds_read_b128 v[124:127], v6 offset:1024
    v_and_b32 v8, 0x1f0, v1
    ds_read_b128 v[68:71], v8 offset:1024
    v_mfma_f32_32x32x16_bf16 v[88:103], v[244:247], v[132:135], v[88:103]
    ds_read_b128 v[128:131], v6 offset:2048
    s_add_u32 m0, s100, 12288
    s_mul_i32 s12, s31, 28
    s_add_u32 s12, s12, s83
    buffer_load_dwordx4 v14, s[52:55], s12 offen lds
    v_mfma_f32_32x32x16_bf16 v[88:103], v[248:251], v[136:139], v[88:103]
    ds_read_b128 v[132:135], v6 offset:3072
    s_add_u32 m0, s100, 12288
    s_mul_i32 s12, s31, 28
    s_add_u32 s12, s12, s83
    s_add_u32 m0, m0, 1024
    s_add_u32 s12, s12, 7168
    buffer_load_dwordx4 v14, s[52:55], s12 offen lds
    v_mfma_f32_32x32x16_bf16 v[88:103], v[252:255], v[140:143], v[88:103]
    ds_read_b128 v[136:139], v6 offset:4096
    s_add_u32 m0, s100, 12288
    s_mul_i32 s12, s31, 28
    s_add_u32 s12, s12, s83
    s_add_u32 m0, m0, 2048
    s_add_u32 s12, s12, 14336
    buffer_load_dwordx4 v14, s[52:55], s12 offen lds
    s_waitcnt lgkmcnt(3)
    v_mfma_f32_32x32x16_bf16 v[88:103], v[52:55], v[68:71], v[88:103]
    v_mfma_f32_32x32x16_bf16 v[104:119], v[144:147], v[120:123], 0
    ds_read_b128 v[140:143], v6 offset:5120
    s_add_u32 m0, s100, 12288
    s_mul_i32 s12, s31, 28
    s_add_u32 s12, s12, s83
    s_add_u32 m0, m0, 3072
    s_add_u32 s12, s12, 21504
    buffer_load_dwordx4 v14, s[52:55], s12 offen lds
    v_rsq_f32 v5, v71
    v_mfma_f32_32x32x16_bf16 v[104:119], v[148:151], v[124:127], v[104:119]
    ds_read_b128 v[120:123], v6 offset:6144
    v_mul_f32 v4, 0xc0135761, v5
    v_mul_f32 v56, v5, v5
    v_mul_f32 v5, v5, v56
    v_mul_f32 v5, 0xbdd2d3e8, v5
    s_waitcnt lgkmcnt(4)
    v_mfma_f32_32x32x16_bf16 v[104:119], v[152:155], v[128:131], v[104:119]
    ds_read_b128 v[124:127], v6 offset:7168
    s_waitcnt lgkmcnt(4)
    v_mfma_f32_32x32x16_bf16 v[104:119], v[156:159], v[132:135], v[104:119]
    v_add_u32 v6, 135168, v1
    ds_read_b128 v[128:131], v6 offset:8192
    v_mul_f32 v56, v88, v88
    v_mul_f32 v57, v89, v89
    v_mul_f32 v58, v90, v90
    v_mul_f32 v59, v91, v91
    s_waitcnt lgkmcnt(4)
    v_mfma_f32_32x32x16_bf16 v[104:119], v[160:163], v[136:139], v[104:119]
    ds_read_b128 v[132:135], v6 offset:9216
    v_fma_f32 v56, v56, v5, v4
    v_fma_f32 v57, v57, v5, v4
    v_fma_f32 v58, v58, v5, v4
    v_fma_f32 v59, v59, v5, v4
    s_waitcnt lgkmcnt(4)
    v_mfma_f32_32x32x16_bf16 v[104:119], v[164:167], v[140:143], v[104:119]
    ds_read_b128 v[136:139], v6 offset:10240
    v_mul_f32 v56, v56, v88
    v_mul_f32 v57, v57, v89
    v_mul_f32 v58, v58, v90
    v_mul_f32 v59, v59, v91
    s_waitcnt lgkmcnt(4)
    v_mfma_f32_32x32x16_bf16 v[104:119], v[168:171], v[120:123], v[104:119]
    ds_read_b128 v[140:143], v6 offset:11264
    v_mul_f32 v60, v92, v92
    v_mul_f32 v61, v93, v93
    v_mul_f32 v62, v94, v94
    v_mul_f32 v63, v95, v95
    s_waitcnt lgkmcnt(4)
    v_mfma_f32_32x32x16_bf16 v[104:119], v[172:175], v[124:127], v[104:119]
    ds_read_b128 v[120:123], v6 offset:12288
    v_fma_f32 v60, v60, v5, v4
    v_fma_f32 v61, v61, v5, v4
    v_fma_f32 v62, v62, v5, v4
    v_fma_f32 v63, v63, v5, v4
    s_add_u32 s12, s81, s26
    buffer_load_dwordx4 v[144:147], v1, s[44:47], s12 offen sc1
    s_waitcnt lgkmcnt(4)
    v_mfma_f32_32x32x16_bf16 v[104:119], v[176:179], v[128:131], v[104:119]
    ds_read_b128 v[124:127], v6 offset:13312
    v_mul_f32 v60, v60, v92
    v_mul_f32 v61, v61, v93
    v_mul_f32 v62, v62, v94
    v_mul_f32 v63, v63, v95
    s_add_u32 s12, s81, s27
    buffer_load_dwordx4 v[148:151], v1, s[44:47], s12 offen sc1
    s_waitcnt lgkmcnt(4)
    v_mfma_f32_32x32x16_bf16 v[104:119], v[180:183], v[132:135], v[104:119]
    ds_read_b128 v[128:131], v6 offset:14336
    v_exp_f32 v56, v56
    v_mul_f32 v96, v96, v88
    v_exp_f32 v57, v57
    v_mul_f32 v97, v97, v89
    s_add_u32 s12, s81, s28
    buffer_load_dwordx4 v[152:155], v1, s[44:47], s12 offen sc1
    s_waitcnt lgkmcnt(4)
    v_mfma_f32_32x32x16_bf16 v[104:119], v[184:187], v[136:139], v[104:119]
    ds_read_b128 v[132:135], v6 offset:15360
    v_exp_f32 v58, v58
    v_mul_f32 v98, v98, v90
    v_exp_f32 v59, v59
    v_mul_f32 v99, v99, v91
    s_add_u32 s12, s81, s29
    buffer_load_dwordx4 v[156:159], v1, s[44:47], s12 offen sc1
    s_waitcnt lgkmcnt(4)
    v_mfma_f32_32x32x16_bf16 v[104:119], v[188:191], v[140:143], v[104:119]
    ds_read_b128 v[136:139], v6 offset:16384
    v_exp_f32 v60, v60
    v_mul_f32 v100, v100, v92
    v_exp_f32 v61, v61
    v_mul_f32 v101, v101, v93
    s_add_u32 s12, s81, s30
    buffer_load_dwordx4 v[160:163], v1, s[44:47], s12 offen sc1
    s_waitcnt lgkmcnt(4)
    v_mfma_f32_32x32x16_bf16 v[104:119], v[192:195], v[120:123], v[104:119]
    ds_read_b128 v[140:143], v6 offset:17408
    s_waitcnt vmcnt(18)
    s_add_u32 s13, s100, 110592
    v_add_u32 v8, s13, v10
    ds_read_b64_tr_b16 v[172:173], v8 offset:0
    ds_read_b64_tr_b16 v[174:175], v8 offset:1024
    v_add_u32 v8, s13, v10
    v_xor_b32 v8, 32, v8
    ds_read_b64_tr_b16 v[176:177], v8 offset:0
    ds_read_b64_tr_b16 v[178:179], v8 offset:1024
    v_exp_f32 v62, v62
    v_mul_f32 v102, v102, v94
    v_exp_f32 v63, v63
    v_mul_f32 v103, v103, v95
    s_add_u32 s12, s81, s31
    buffer_load_dwordx4 v[164:167], v1, s[44:47], s12 offen sc1
    s_setprio 3
    s_waitcnt lgkmcnt(8)
    v_mfma_f32_32x32x16_bf16 v[104:119], v[196:199], v[124:127], v[104:119]
    ds_read_b128 v[120:123], v6 offset:18432
    s_add_u32 s13, s100, 110592
    v_add_u32 v8, s13, v10
    v_xor_b32 v8, 64, v8
    ds_read_b64_tr_b16 v[180:181], v8 offset:0
    ds_read_b64_tr_b16 v[182:183], v8 offset:1024
    v_add_u32 v8, s13, v10
    v_xor_b32 v8, 96, v8
    ds_read_b64_tr_b16 v[184:185], v8 offset:0
    ds_read_b64_tr_b16 v[186:187], v8 offset:1024
    v_fma_f32 v56, v56, v71, v71
    v_fma_f32 v57, v57, v71, v71
    v_rcp_f32 v56, v56
    v_rcp_f32 v57, v57
    s_add_u32 s12, s81, s32
    buffer_load_dwordx4 v[168:171], v1, s[44:47], s12 offen sc1
    s_waitcnt lgkmcnt(12)
    v_mfma_f32_32x32x16_bf16 v[104:119], v[200:203], v[128:131], v[104:119]
    ds_read_b128 v[124:127], v6 offset:19456
    v_fma_f32 v58, v58, v71, v71
    v_fma_f32 v59, v59, v71, v71
    v_rcp_f32 v58, v58
    v_rcp_f32 v59, v59
    s_waitcnt lgkmcnt(12)
    v_mfma_f32_32x32x16_bf16 v[104:119], v[204:207], v[132:135], v[104:119]
    ds_read_b128 v[128:131], v6 offset:20480
    v_fma_f32 v60, v60, v71, v71
    v_fma_f32 v61, v61, v71, v71
    v_rcp_f32 v60, v60
    v_rcp_f32 v61, v61
    s_waitcnt lgkmcnt(12)
    v_mfma_f32_32x32x16_bf16 v[104:119], v[208:211], v[136:139], v[104:119]
    ds_read_b128 v[132:135], v6 offset:21504
    s_waitcnt vmcnt(16)
    s_add_u32 s13, s100, 45056
    v_add_u32 v8, s13, v10
    ds_read_b64_tr_b16 v[188:189], v8 offset:0
    ds_read_b64_tr_b16 v[190:191], v8 offset:1024
    v_add_u32 v8, s13, v10
    v_xor_b32 v8, 32, v8
    ds_read_b64_tr_b16 v[192:193], v8 offset:0
    ds_read_b64_tr_b16 v[194:195], v8 offset:1024
    v_fma_f32 v62, v62, v71, v71
    v_fma_f32 v63, v63, v71, v71
    v_rcp_f32 v62, v62
    v_rcp_f32 v63, v63
    s_waitcnt lgkmcnt(15)
    v_mfma_f32_32x32x16_bf16 v[104:119], v[212:215], v[140:143], v[104:119]
    ds_read_b128 v[136:139], v6 offset:22528
    s_add_u32 s13, s100, 45056
    v_add_u32 v8, s13, v10
    v_xor_b32 v8, 64, v8
    ds_read_b64_tr_b16 v[196:197], v8 offset:0
    ds_read_b64_tr_b16 v[198:199], v8 offset:1024
    v_add_u32 v8, s13, v10
    v_xor_b32 v8, 96, v8
    ds_read_b64_tr_b16 v[200:201], v8 offset:0
    ds_read_b64_tr_b16 v[202:203], v8 offset:1024
    v_mul_f32 v56, v56, v96
    v_mul_f32 v57, v57, v97
    v_mul_f32 v58, v58, v98
    v_mul_f32 v59, v59, v99
    s_waitcnt lgkmcnt(15)
    v_mfma_f32_32x32x16_bf16 v[104:119], v[216:219], v[120:123], v[104:119]
    ds_read_b128 v[140:143], v6 offset:23552
    v_mul_f32 v60, v60, v100
    v_mul_f32 v61, v61, v101
    v_mul_f32 v62, v62, v102
    v_mul_f32 v63, v63, v103
    s_waitcnt lgkmcnt(12)
    v_mfma_f32_32x32x16_bf16 v[104:119], v[220:223], v[124:127], v[104:119]
    ds_read_b128 v[120:123], v6 offset:24576
    v_cvt_pk_bf16_f32 v56, v56, v57
    v_cvt_pk_bf16_f32 v57, v58, v59
    v_cvt_pk_bf16_f32 v58, v60, v61
    v_cvt_pk_bf16_f32 v59, v62, v63
    s_add_u32 s43, s43, 114688
    buffer_store_dwordx4 v[56:59], v7, s[44:47], s43 offen sc1
    s_waitcnt lgkmcnt(12)
    v_mfma_f32_32x32x16_bf16 v[104:119], v[224:227], v[128:131], v[104:119]
    ds_read_b128 v[124:127], v6 offset:25600
    s_waitcnt vmcnt(8)
    s_add_u32 s13, s100, 12288
    v_add_u32 v8, s13, v10
    ds_read_b64_tr_b16 v[204:205], v8 offset:0
    ds_read_b64_tr_b16 v[206:207], v8 offset:1024
    v_add_u32 v8, s13, v10
    v_xor_b32 v8, 32, v8
    ds_read_b64_tr_b16 v[208:209], v8 offset:0
    ds_read_b64_tr_b16 v[210:211], v8 offset:1024
    s_waitcnt lgkmcnt(15)
    v_mfma_f32_32x32x16_bf16 v[104:119], v[228:231], v[132:135], v[104:119]
    ds_read_b128 v[128:131], v6 offset:26624
    s_add_u32 s13, s100, 12288
    v_add_u32 v8, s13, v10
    v_xor_b32 v8, 64, v8
    ds_read_b64_tr_b16 v[212:213], v8 offset:0
    ds_read_b64_tr_b16 v[214:215], v8 offset:1024
    v_add_u32 v8, s13, v10
    v_xor_b32 v8, 96, v8
    ds_read_b64_tr_b16 v[216:217], v8 offset:0
    ds_read_b64_tr_b16 v[218:219], v8 offset:1024
    s_waitcnt lgkmcnt(15)
    v_mfma_f32_32x32x16_bf16 v[104:119], v[232:235], v[136:139], v[104:119]
    ds_read_b128 v[132:135], v6 offset:27648
    s_waitcnt lgkmcnt(12)
    v_mfma_f32_32x32x16_bf16 v[104:119], v[236:239], v[140:143], v[104:119]
    s_add_u32 s12, s81, s26
    s_add_u32 s12, s12, 114688
    buffer_load_dwordx4 v[88:91], v1, s[44:47], s12 offen sc1
    s_waitcnt lgkmcnt(11)
    v_mfma_f32_32x32x16_bf16 v[104:119], v[240:243], v[120:123], v[104:119]
    s_add_u32 s13, s100, 77824
    v_add_u32 v8, s13, v10
    ds_read_b64_tr_b16 v[220:221], v8 offset:0
    ds_read_b64_tr_b16 v[222:223], v8 offset:1024
    v_add_u32 v8, s13, v10
    v_xor_b32 v8, 32, v8
    ds_read_b64_tr_b16 v[224:225], v8 offset:0
    ds_read_b64_tr_b16 v[226:227], v8 offset:1024
    s_add_u32 s12, s81, s27
    s_add_u32 s12, s12, 114688
    buffer_load_dwordx4 v[92:95], v1, s[44:47], s12 offen sc1
    s_waitcnt lgkmcnt(14)
    v_mfma_f32_32x32x16_bf16 v[104:119], v[244:247], v[124:127], v[104:119]
    s_add_u32 s13, s100, 77824
    v_add_u32 v8, s13, v10
    v_xor_b32 v8, 64, v8
    ds_read_b64_tr_b16 v[228:229], v8 offset:0
    ds_read_b64_tr_b16 v[230:231], v8 offset:1024
    v_add_u32 v8, s13, v10
    v_xor_b32 v8, 96, v8
    ds_read_b64_tr_b16 v[232:233], v8 offset:0
    ds_read_b64_tr_b16 v[234:235], v8 offset:1024
    s_add_u32 s12, s81, s28
    s_add_u32 s12, s12, 114688
    buffer_load_dwordx4 v[96:99], v1, s[44:47], s12 offen sc1
    v_and_b32 v8, 0x1f0, v1
    ds_read_b128 v[68:71], v8 offset:1536
    s_waitcnt lgkmcnt(14)
    v_mfma_f32_32x32x16_bf16 v[104:119], v[248:251], v[128:131], v[104:119]
    s_add_u32 s12, s81, s29
    s_add_u32 s12, s12, 114688
    buffer_load_dwordx4 v[100:103], v1, s[44:47], s12 offen sc1
    s_waitcnt lgkmcnt(9)
    v_mfma_f32_32x32x16_bf16 v[104:119], v[252:255], v[132:135], v[104:119]
    s_waitcnt lgkmcnt(0)
    v_mfma_f32_32x32x16_bf16 v[104:119], v[52:55], v[68:71], v[104:119]
    s_add_u32 s12, s81, s30
    s_add_u32 s12, s12, 114688
    buffer_load_dwordx4 v[236:239], v1, s[44:47], s12 offen sc1
    s_add_u32 s12, s81, s31
    s_add_u32 s12, s12, 114688
    buffer_load_dwordx4 v[240:243], v1, s[44:47], s12 offen sc1
    s_add_u32 s12, s81, s32
    s_add_u32 s12, s12, 114688
    buffer_load_dwordx4 v[244:247], v1, s[44:47], s12 offen sc1
    v_rsq_f32 v5, v71
    s_nop 0
    v_mul_f32 v4, 0xc0135761, v5
    v_mul_f32 v56, v5, v5
    v_mul_f32 v5, v5, v56
    v_mul_f32 v5, 0xbdd2d3e8, v5
    v_pk_mul_f32 v[56:57], v[104:105], v[104:105]
    v_pk_mul_f32 v[58:59], v[106:107], v[106:107]
    v_pk_fma_f32 v[56:57], v[56:57], v[4:5], v[4:5] op_sel:[0,1,0] op_sel_hi:[1,1,0]
    v_pk_fma_f32 v[58:59], v[58:59], v[4:5], v[4:5] op_sel:[0,1,0] op_sel_hi:[1,1,0]
    v_pk_mul_f32 v[56:57], v[56:57], v[104:105]
    v_pk_mul_f32 v[58:59], v[58:59], v[106:107]
    v_pk_mul_f32 v[60:61], v[108:109], v[108:109]
    v_pk_mul_f32 v[62:63], v[110:111], v[110:111]
    v_pk_fma_f32 v[60:61], v[60:61], v[4:5], v[4:5] op_sel:[0,1,0] op_sel_hi:[1,1,0]
    v_pk_fma_f32 v[62:63], v[62:63], v[4:5], v[4:5] op_sel:[0,1,0] op_sel_hi:[1,1,0]
    v_pk_mul_f32 v[60:61], v[60:61], v[108:109]
    v_pk_mul_f32 v[62:63], v[62:63], v[110:111]
    v_exp_f32 v56, v56
    v_pk_mul_f32 v[112:113], v[112:113], v[104:105]
    v_exp_f32 v57, v57
    v_exp_f32 v58, v58
    v_pk_mul_f32 v[114:115], v[114:115], v[106:107]
    v_exp_f32 v59, v59
    v_exp_f32 v60, v60
    v_pk_mul_f32 v[116:117], v[116:117], v[108:109]
    v_exp_f32 v61, v61
    v_exp_f32 v62, v62
    v_pk_mul_f32 v[118:119], v[118:119], v[110:111]
    v_exp_f32 v63, v63
    v_pk_fma_f32 v[56:57], v[56:57], v[70:71], v[70:71] op_sel:[0,1,1] op_sel_hi:[1,1,1]
    v_rcp_f32 v56, v56
    v_rcp_f32 v57, v57
    v_pk_fma_f32 v[58:59], v[58:59], v[70:71], v[70:71] op_sel:[0,1,1] op_sel_hi:[1,1,1]
    v_rcp_f32 v58, v58
    v_rcp_f32 v59, v59
    v_pk_fma_f32 v[60:61], v[60:61], v[70:71], v[70:71] op_sel:[0,1,1] op_sel_hi:[1,1,1]
    v_rcp_f32 v60, v60
    v_rcp_f32 v61, v61
    v_pk_fma_f32 v[62:63], v[62:63], v[70:71], v[70:71] op_sel:[0,1,1] op_sel_hi:[1,1,1]
    v_rcp_f32 v62, v62
    v_rcp_f32 v63, v63
    v_pk_mul_f32 v[56:57], v[56:57], v[112:113]
    v_pk_mul_f32 v[58:59], v[58:59], v[114:115]
    v_pk_mul_f32 v[60:61], v[60:61], v[116:117]
    v_pk_mul_f32 v[62:63], v[62:63], v[118:119]
    v_cvt_pk_bf16_f32 v56, v56, v57
    v_cvt_pk_bf16_f32 v57, v58, v59
    v_cvt_pk_bf16_f32 v58, v60, v61
    v_cvt_pk_bf16_f32 v59, v62, v63
    s_add_u32 s43, s43, 114688
    buffer_store_dwordx4 v[56:59], v7, s[44:47], s43 offen sc1
    s_setprio 0
    s_cmp_lt_u32 s3, 4
    s_cbranch_scc1 pr_96
    s_setprio 2
pr_96:
    s_waitcnt vmcnt(9)
    v_max3_u32 v8, v144, v148, v152
    v_max3_u32 v8, v8, v156, v160
    v_max3_u32 v8, v8, v164, v168
    v_cmp_eq_u32 vcc, -1, v8
    s_cbranch_vccz pd_98
pc_97:
    s_cmp_eq_u32 s11, 0
    s_cbranch_scc1 pd_98
    s_sub_u32 s11, s11, 1
    v_cmp_eq_u32 vcc, -1, v144
    s_cbranch_vccz ps_99
    s_add_u32 s12, s81, s26
    buffer_load_dwordx4 v[144:147], v1, s[44:47], s12 offen sc1
ps_99:
    v_cmp_eq_u32 vcc, -1, v148
    s_cbranch_vccz ps_100
    s_add_u32 s12, s81, s27
    buffer_load_dwordx4 v[148:151], v1, s[44:47], s12 offen sc1
ps_100:
    v_cmp_eq_u32 vcc, -1, v152
    s_cbranch_vccz ps_101
    s_add_u32 s12, s81, s28
    buffer_load_dwordx4 v[152:155], v1, s[44:47], s12 offen sc1
ps_101:
    v_cmp_eq_u32 vcc, -1, v156
    s_cbranch_vccz ps_102
    s_add_u32 s12, s81, s29
    buffer_load_dwordx4 v[156:159], v1, s[44:47], s12 offen sc1
ps_102:
    v_cmp_eq_u32 vcc, -1, v160
    s_cbranch_vccz ps_103
    s_add_u32 s12, s81, s30
    buffer_load_dwordx4 v[160:163], v1, s[44:47], s12 offen sc1
ps_103:
    v_cmp_eq_u32 vcc, -1, v164
    s_cbranch_vccz ps_104
    s_add_u32 s12, s81, s31
    buffer_load_dwordx4 v[164:167], v1, s[44:47], s12 offen sc1
ps_104:
    v_cmp_eq_u32 vcc, -1, v168
    s_cbranch_vccz ps_105
    s_add_u32 s12, s81, s32
    buffer_load_dwordx4 v[168:171], v1, s[44:47], s12 offen sc1
ps_105:
    s_waitcnt vmcnt(0)
    v_max3_u32 v8, v144, v148, v152
    v_max3_u32 v8, v8, v156, v160
    v_max3_u32 v8, v8, v164, v168
    v_cmp_eq_u32 vcc, -1, v8
    s_waitcnt lgkmcnt(0)
    s_cbranch_vccnz pc_97
    s_nop 4
pd_98:
    v_mfma_f32_16x16x32_bf16 v[120:123], v[16:19], v[144:147], 0
    v_mfma_f32_16x16x32_bf16 v[124:127], v[20:23], v[144:147], 0
    v_mfma_f32_16x16x32_bf16 v[128:131], v[24:27], v[144:147], 0
    v_mfma_f32_16x16x32_bf16 v[132:135], v[28:31], v[144:147], 0
    v_mfma_f32_16x16x32_bf16 v[120:123], v[32:35], v[148:151], v[120:123]
    v_mfma_f32_16x16x32_bf16 v[124:127], v[36:39], v[148:151], v[124:127]
    v_mfma_f32_16x16x32_bf16 v[128:131], v[40:43], v[148:151], v[128:131]
    v_mfma_f32_16x16x32_bf16 v[132:135], v[44:47], v[148:151], v[132:135]
    v_mfma_f32_16x16x32_bf16 v[120:123], v[72:75], v[152:155], v[120:123]
    v_mfma_f32_16x16x32_bf16 v[124:127], v[76:79], v[152:155], v[124:127]
    v_mfma_f32_16x16x32_bf16 v[128:131], v[80:83], v[152:155], v[128:131]
    v_mfma_f32_16x16x32_bf16 v[132:135], v[84:87], v[152:155], v[132:135]
    v_mfma_f32_16x16x32_bf16 v[120:123], v[172:175], v[156:159], v[120:123]
    v_mfma_f32_16x16x32_bf16 v[124:127], v[176:179], v[156:159], v[124:127]
    v_mfma_f32_16x16x32_bf16 v[128:131], v[180:183], v[156:159], v[128:131]
    v_mfma_f32_16x16x32_bf16 v[132:135], v[184:187], v[156:159], v[132:135]
    v_mfma_f32_16x16x32_bf16 v[120:123], v[188:191], v[160:163], v[120:123]
    v_mfma_f32_16x16x32_bf16 v[124:127], v[192:195], v[160:163], v[124:127]
    v_mfma_f32_16x16x32_bf16 v[128:131], v[196:199], v[160:163], v[128:131]
    v_mfma_f32_16x16x32_bf16 v[132:135], v[200:203], v[160:163], v[132:135]
    v_mfma_f32_16x16x32_bf16 v[120:123], v[204:207], v[164:167], v[120:123]
    v_mfma_f32_16x16x32_bf16 v[124:127], v[208:211], v[164:167], v[124:127]
    v_mfma_f32_16x16x32_bf16 v[128:131], v[212:215], v[164:167], v[128:131]
    v_mfma_f32_16x16x32_bf16 v[132:135], v[216:219], v[164:167], v[132:135]
    v_mfma_f32_16x16x32_bf16 v[120:123], v[220:223], v[168:171], v[120:123]
    v_mfma_f32_16x16x32_bf16 v[124:127], v[224:227], v[168:171], v[124:127]
    v_mfma_f32_16x16x32_bf16 v[128:131], v[228:231], v[168:171], v[128:131]
    v_mfma_f32_16x16x32_bf16 v[132:135], v[232:235], v[168:171], v[132:135]
    s_add_u32 s12, s81, s26
    s_add_u32 s12, s12, 229376
    buffer_load_dwordx4 v[144:147], v1, s[44:47], s12 offen sc1
    s_add_u32 s12, s81, s27
    s_add_u32 s12, s12, 229376
    buffer_load_dwordx4 v[148:151], v1, s[44:47], s12 offen sc1
    s_add_u32 s12, s81, s28
    s_add_u32 s12, s12, 229376
    buffer_load_dwordx4 v[152:155], v1, s[44:47], s12 offen sc1
    s_add_u32 s12, s81, s29
    s_add_u32 s12, s12, 229376
    buffer_load_dwordx4 v[156:159], v1, s[44:47], s12 offen sc1
    s_add_u32 s12, s81, s30
    s_add_u32 s12, s12, 229376
    buffer_load_dwordx4 v[160:163], v1, s[44:47], s12 offen sc1
    s_add_u32 s12, s81, s31
    s_add_u32 s12, s12, 229376
    buffer_load_dwordx4 v[164:167], v1, s[44:47], s12 offen sc1
    s_add_u32 s12, s81, s32
    s_add_u32 s12, s12, 229376
    buffer_load_dwordx4 v[168:171], v1, s[44:47], s12 offen sc1
    s_add_u32 s13, s100, 77824
    v_add_u32 v8, s13, v1
    ds_write_b128 v8, v[120:123] offset:0
    ds_write_b128 v8, v[124:127] offset:1024
    ds_write_b128 v8, v[128:131] offset:2048
    ds_write_b128 v8, v[132:135] offset:3072
    s_waitcnt vmcnt(8)
    v_max3_u32 v8, v88, v92, v96
    v_max3_u32 v8, v8, v100, v236
    v_max3_u32 v8, v8, v240, v244
    v_cmp_eq_u32 vcc, -1, v8
    s_cbranch_vccz pd_107
pc_106:
    s_cmp_eq_u32 s11, 0
    s_cbranch_scc1 pd_107
    s_sub_u32 s11, s11, 1
    v_cmp_eq_u32 vcc, -1, v88
    s_cbranch_vccz ps_108
    s_add_u32 s12, s81, s26
    s_add_u32 s12, s12, 114688
    buffer_load_dwordx4 v[88:91], v1, s[44:47], s12 offen sc1
ps_108:
    v_cmp_eq_u32 vcc, -1, v92
    s_cbranch_vccz ps_109
    s_add_u32 s12, s81, s27
    s_add_u32 s12, s12, 114688
    buffer_load_dwordx4 v[92:95], v1, s[44:47], s12 offen sc1
ps_109:
    v_cmp_eq_u32 vcc, -1, v96
    s_cbranch_vccz ps_110
    s_add_u32 s12, s81, s28
    s_add_u32 s12, s12, 114688
    buffer_load_dwordx4 v[96:99], v1, s[44:47], s12 offen sc1
ps_110:
    v_cmp_eq_u32 vcc, -1, v100
    s_cbranch_vccz ps_111
    s_add_u32 s12, s81, s29
    s_add_u32 s12, s12, 114688
    buffer_load_dwordx4 v[100:103], v1, s[44:47], s12 offen sc1
ps_111:
    v_cmp_eq_u32 vcc, -1, v236
    s_cbranch_vccz ps_112
    s_add_u32 s12, s81, s30
    s_add_u32 s12, s12, 114688
    buffer_load_dwordx4 v[236:239], v1, s[44:47], s12 offen sc1
ps_112:
    v_cmp_eq_u32 vcc, -1, v240
    s_cbranch_vccz ps_113
    s_add_u32 s12, s81, s31
    s_add_u32 s12, s12, 114688
    buffer_load_dwordx4 v[240:243], v1, s[44:47], s12 offen sc1
ps_113:
    v_cmp_eq_u32 vcc, -1, v244
    s_cbranch_vccz ps_114
    s_add_u32 s12, s81, s32
    s_add_u32 s12, s12, 114688
    buffer_load_dwordx4 v[244:247], v1, s[44:47], s12 offen sc1
ps_114:
    s_waitcnt vmcnt(0)
    v_max3_u32 v8, v88, v92, v96
    v_max3_u32 v8, v8, v100, v236
    v_max3_u32 v8, v8, v240, v244
    v_cmp_eq_u32 vcc, -1, v8
    s_waitcnt lgkmcnt(0)
    s_cbranch_vccnz pc_106
    s_nop 4
pd_107:
    v_mfma_f32_16x16x32_bf16 v[104:107], v[16:19], v[88:91], 0
    v_mfma_f32_16x16x32_bf16 v[108:111], v[20:23], v[88:91], 0
    v_mfma_f32_16x16x32_bf16 v[112:115], v[24:27], v[88:91], 0
    v_mfma_f32_16x16x32_bf16 v[116:119], v[28:31], v[88:91], 0
    v_mfma_f32_16x16x32_bf16 v[104:107], v[32:35], v[92:95], v[104:107]
    v_mfma_f32_16x16x32_bf16 v[108:111], v[36:39], v[92:95], v[108:111]
    v_mfma_f32_16x16x32_bf16 v[112:115], v[40:43], v[92:95], v[112:115]
    v_mfma_f32_16x16x32_bf16 v[116:119], v[44:47], v[92:95], v[116:119]
    v_mfma_f32_16x16x32_bf16 v[104:107], v[72:75], v[96:99], v[104:107]
    v_mfma_f32_16x16x32_bf16 v[108:111], v[76:79], v[96:99], v[108:111]
    v_mfma_f32_16x16x32_bf16 v[112:115], v[80:83], v[96:99], v[112:115]
    v_mfma_f32_16x16x32_bf16 v[116:119], v[84:87], v[96:99], v[116:119]
    v_mfma_f32_16x16x32_bf16 v[104:107], v[172:175], v[100:103], v[104:107]
    v_mfma_f32_16x16x32_bf16 v[108:111], v[176:179], v[100:103], v[108:111]
    v_mfma_f32_16x16x32_bf16 v[112:115], v[180:183], v[100:103], v[112:115]
    v_mfma_f32_16x16x32_bf16 v[116:119], v[184:187], v[100:103], v[116:119]
    v_mfma_f32_16x16x32_bf16 v[104:107], v[188:191], v[236:239], v[104:107]
    v_mfma_f32_16x16x32_bf16 v[108:111], v[192:195], v[236:239], v[108:111]
    v_mfma_f32_16x16x32_bf16 v[112:115], v[196:199], v[236:239], v[112:115]
    v_mfma_f32_16x16x32_bf16 v[116:119], v[200:203], v[236:239], v[116:119]
    v_mfma_f32_16x16x32_bf16 v[104:107], v[204:207], v[240:243], v[104:107]
    v_mfma_f32_16x16x32_bf16 v[108:111], v[208:211], v[240:243], v[108:111]
    v_mfma_f32_16x16x32_bf16 v[112:115], v[212:215], v[240:243], v[112:115]
    v_mfma_f32_16x16x32_bf16 v[116:119], v[216:219], v[240:243], v[116:119]
    v_mfma_f32_16x16x32_bf16 v[104:107], v[220:223], v[244:247], v[104:107]
    v_mfma_f32_16x16x32_bf16 v[108:111], v[224:227], v[244:247], v[108:111]
    v_mfma_f32_16x16x32_bf16 v[112:115], v[228:231], v[244:247], v[112:115]
    v_mfma_f32_16x16x32_bf16 v[116:119], v[232:235], v[244:247], v[116:119]
    s_add_u32 s12, s81, s26
    s_add_u32 s12, s12, 344064
    buffer_load_dwordx4 v[88:91], v1, s[44:47], s12 offen sc1
    s_add_u32 s12, s81, s27
    s_add_u32 s12, s12, 344064
    buffer_load_dwordx4 v[92:95], v1, s[44:47], s12 offen sc1
    s_add_u32 s12, s81, s28
    s_add_u32 s12, s12, 344064
    buffer_load_dwordx4 v[96:99], v1, s[44:47], s12 offen sc1
    s_add_u32 s12, s81, s29
    s_add_u32 s12, s12, 344064
    buffer_load_dwordx4 v[100:103], v1, s[44:47], s12 offen sc1
    s_add_u32 s12, s81, s30
    s_add_u32 s12, s12, 344064
    buffer_load_dwordx4 v[236:239], v1, s[44:47], s12 offen sc1
    s_add_u32 s12, s81, s31
    s_add_u32 s12, s12, 344064
    buffer_load_dwordx4 v[240:243], v1, s[44:47], s12 offen sc1
    s_add_u32 s12, s81, s32
    s_add_u32 s12, s12, 344064
    buffer_load_dwordx4 v[244:247], v1, s[44:47], s12 offen sc1
    s_add_u32 s13, s100, 12288
    v_add_u32 v8, s13, v1
    ds_write_b128 v8, v[104:107] offset:0
    ds_write_b128 v8, v[108:111] offset:1024
    ds_write_b128 v8, v[112:115] offset:2048
    ds_write_b128 v8, v[116:119] offset:3072
    v_lshrrev_b32 v4, 8, v1
    v_and_b32 v5, 0xf0, v1
    v_mul_u32_u24 v14, 56, v5
    v_lshl_add_u32 v14, v4, 3, v14
    s_lshl_b32 s12, s8, 10
    s_cmp_lt_u32 s3, 4
    s_mov_b32 s13, 12288
    s_cmov_b32 s13, 77824
    s_add_u32 s14, s12, s13
    v_add_u32 v12, s14, v1
    s_waitcnt vmcnt(7)
    v_max3_u32 v8, v144, v148, v152
    v_max3_u32 v8, v8, v156, v160
    v_max3_u32 v8, v8, v164, v168
    v_cmp_eq_u32 vcc, -1, v8
    s_cbranch_vccz pd_116
pc_115:
    s_cmp_eq_u32 s11, 0
    s_cbranch_scc1 pd_116
    s_sub_u32 s11, s11, 1
    v_cmp_eq_u32 vcc, -1, v144
    s_cbranch_vccz ps_117
    s_add_u32 s12, s81, s26
    s_add_u32 s12, s12, 229376
    buffer_load_dwordx4 v[144:147], v1, s[44:47], s12 offen sc1
ps_117:
    v_cmp_eq_u32 vcc, -1, v148
    s_cbranch_vccz ps_118
    s_add_u32 s12, s81, s27
    s_add_u32 s12, s12, 229376
    buffer_load_dwordx4 v[148:151], v1, s[44:47], s12 offen sc1
ps_118:
    v_cmp_eq_u32 vcc, -1, v152
    s_cbranch_vccz ps_119
    s_add_u32 s12, s81, s28
    s_add_u32 s12, s12, 229376
    buffer_load_dwordx4 v[152:155], v1, s[44:47], s12 offen sc1
ps_119:
    v_cmp_eq_u32 vcc, -1, v156
    s_cbranch_vccz ps_120
    s_add_u32 s12, s81, s29
    s_add_u32 s12, s12, 229376
    buffer_load_dwordx4 v[156:159], v1, s[44:47], s12 offen sc1
ps_120:
    v_cmp_eq_u32 vcc, -1, v160
    s_cbranch_vccz ps_121
    s_add_u32 s12, s81, s30
    s_add_u32 s12, s12, 229376
    buffer_load_dwordx4 v[160:163], v1, s[44:47], s12 offen sc1
ps_121:
    v_cmp_eq_u32 vcc, -1, v164
    s_cbranch_vccz ps_122
    s_add_u32 s12, s81, s31
    s_add_u32 s12, s12, 229376
    buffer_load_dwordx4 v[164:167], v1, s[44:47], s12 offen sc1
ps_122:
    v_cmp_eq_u32 vcc, -1, v168
    s_cbranch_vccz ps_123
    s_add_u32 s12, s81, s32
    s_add_u32 s12, s12, 229376
    buffer_load_dwordx4 v[168:171], v1, s[44:47], s12 offen sc1
ps_123:
    s_waitcnt vmcnt(0)
    v_max3_u32 v8, v144, v148, v152
    v_max3_u32 v8, v8, v156, v160
    v_max3_u32 v8, v8, v164, v168
    v_cmp_eq_u32 vcc, -1, v8
    s_waitcnt lgkmcnt(0)
    s_cbranch_vccnz pc_115
    s_nop 4
pd_116:
    v_mfma_f32_16x16x32_bf16 v[120:123], v[16:19], v[144:147], 0
    v_mfma_f32_16x16x32_bf16 v[124:127], v[20:23], v[144:147], 0
    v_mfma_f32_16x16x32_bf16 v[128:131], v[24:27], v[144:147], 0
    v_mfma_f32_16x16x32_bf16 v[132:135], v[28:31], v[144:147], 0
    v_mfma_f32_16x16x32_bf16 v[120:123], v[32:35], v[148:151], v[120:123]
    v_mfma_f32_16x16x32_bf16 v[124:127], v[36:39], v[148:151], v[124:127]
    v_mfma_f32_16x16x32_bf16 v[128:131], v[40:43], v[148:151], v[128:131]
    v_mfma_f32_16x16x32_bf16 v[132:135], v[44:47], v[148:151], v[132:135]
    v_mfma_f32_16x16x32_bf16 v[120:123], v[72:75], v[152:155], v[120:123]
    v_mfma_f32_16x16x32_bf16 v[124:127], v[76:79], v[152:155], v[124:127]
    v_mfma_f32_16x16x32_bf16 v[128:131], v[80:83], v[152:155], v[128:131]
    v_mfma_f32_16x16x32_bf16 v[132:135], v[84:87], v[152:155], v[132:135]
    v_mfma_f32_16x16x32_bf16 v[120:123], v[172:175], v[156:159], v[120:123]
    v_mfma_f32_16x16x32_bf16 v[124:127], v[176:179], v[156:159], v[124:127]
    v_mfma_f32_16x16x32_bf16 v[128:131], v[180:183], v[156:159], v[128:131]
    v_mfma_f32_16x16x32_bf16 v[132:135], v[184:187], v[156:159], v[132:135]
    v_mfma_f32_16x16x32_bf16 v[120:123], v[188:191], v[160:163], v[120:123]
    v_mfma_f32_16x16x32_bf16 v[124:127], v[192:195], v[160:163], v[124:127]
    v_mfma_f32_16x16x32_bf16 v[128:131], v[196:199], v[160:163], v[128:131]
    v_mfma_f32_16x16x32_bf16 v[132:135], v[200:203], v[160:163], v[132:135]
    v_mfma_f32_16x16x32_bf16 v[120:123], v[204:207], v[164:167], v[120:123]
    v_mfma_f32_16x16x32_bf16 v[124:127], v[208:211], v[164:167], v[124:127]
    v_mfma_f32_16x16x32_bf16 v[128:131], v[212:215], v[164:167], v[128:131]
    v_mfma_f32_16x16x32_bf16 v[132:135], v[216:219], v[164:167], v[132:135]
    v_mfma_f32_16x16x32_bf16 v[120:123], v[220:223], v[168:171], v[120:123]
    v_mfma_f32_16x16x32_bf16 v[124:127], v[224:227], v[168:171], v[124:127]
    v_mfma_f32_16x16x32_bf16 v[128:131], v[228:231], v[168:171], v[128:131]
    v_mfma_f32_16x16x32_bf16 v[132:135], v[232:235], v[168:171], v[132:135]
    s_setprio 0
    s_add_u32 s13, s100, 110592
    v_add_u32 v8, s13, v1
    s_nop 1
    ds_write_b128 v8, v[120:123] offset:0
    ds_write_b128 v8, v[124:127] offset:1024
    ds_write_b128 v8, v[128:131] offset:2048
    ds_write_b128 v8, v[132:135] offset:3072
    s_waitcnt vmcnt(0)
    v_max3_u32 v8, v88, v92, v96
    v_max3_u32 v8, v8, v100, v236
    v_max3_u32 v8, v8, v240, v244
    v_cmp_eq_u32 vcc, -1, v8
    s_cbranch_vccz pd_125
pc_124:
    s_cmp_eq_u32 s11, 0
    s_cbranch_scc1 pd_125
    s_sub_u32 s11, s11, 1
    v_cmp_eq_u32 vcc, -1, v88
    s_cbranch_vccz ps_126
    s_add_u32 s12, s81, s26
    s_add_u32 s12, s12, 344064
    buffer_load_dwordx4 v[88:91], v1, s[44:47], s12 offen sc1
ps_126:
    v_cmp_eq_u32 vcc, -1, v92
    s_cbranch_vccz ps_127
    s_add_u32 s12, s81, s27
    s_add_u32 s12, s12, 344064
    buffer_load_dwordx4 v[92:95], v1, s[44:47], s12 offen sc1
ps_127:
    v_cmp_eq_u32 vcc, -1, v96
    s_cbranch_vccz ps_128
    s_add_u32 s12, s81, s28
    s_add_u32 s12, s12, 344064
    buffer_load_dwordx4 v[96:99], v1, s[44:47], s12 offen sc1
ps_128:
    v_cmp_eq_u32 vcc, -1, v100
    s_cbranch_vccz ps_129
    s_add_u32 s12, s81, s29
    s_add_u32 s12, s12, 344064
    buffer_load_dwordx4 v[100:103], v1, s[44:47], s12 offen sc1
ps_129:
    v_cmp_eq_u32 vcc, -1, v236
    s_cbranch_vccz ps_130
    s_add_u32 s12, s81, s30
    s_add_u32 s12, s12, 344064
    buffer_load_dwordx4 v[236:239], v1, s[44:47], s12 offen sc1
ps_130:
    v_cmp_eq_u32 vcc, -1, v240
    s_cbranch_vccz ps_131
    s_add_u32 s12, s81, s31
    s_add_u32 s12, s12, 344064
    buffer_load_dwordx4 v[240:243], v1, s[44:47], s12 offen sc1
ps_131:
    v_cmp_eq_u32 vcc, -1, v244
    s_cbranch_vccz ps_132
    s_add_u32 s12, s81, s32
    s_add_u32 s12, s12, 344064
    buffer_load_dwordx4 v[244:247], v1, s[44:47], s12 offen sc1
ps_132:
    s_waitcnt vmcnt(0)
    v_max3_u32 v8, v88, v92, v96
    v_max3_u32 v8, v8, v100, v236
    v_max3_u32 v8, v8, v240, v244
    v_cmp_eq_u32 vcc, -1, v8
    s_waitcnt lgkmcnt(0)
    s_cbranch_vccnz pc_124
    s_nop 4
pd_125:
    v_mfma_f32_16x16x32_bf16 v[104:107], v[16:19], v[88:91], 0
    v_mfma_f32_16x16x32_bf16 v[108:111], v[20:23], v[88:91], 0
    v_mfma_f32_16x16x32_bf16 v[112:115], v[24:27], v[88:91], 0
    v_mfma_f32_16x16x32_bf16 v[116:119], v[28:31], v[88:91], 0
    v_mfma_f32_16x16x32_bf16 v[104:107], v[32:35], v[92:95], v[104:107]
    v_mfma_f32_16x16x32_bf16 v[108:111], v[36:39], v[92:95], v[108:111]
    v_mfma_f32_16x16x32_bf16 v[112:115], v[40:43], v[92:95], v[112:115]
    v_mfma_f32_16x16x32_bf16 v[116:119], v[44:47], v[92:95], v[116:119]
    v_mfma_f32_16x16x32_bf16 v[104:107], v[72:75], v[96:99], v[104:107]
    v_mfma_f32_16x16x32_bf16 v[108:111], v[76:79], v[96:99], v[108:111]
    v_mfma_f32_16x16x32_bf16 v[112:115], v[80:83], v[96:99], v[112:115]
    v_mfma_f32_16x16x32_bf16 v[116:119], v[84:87], v[96:99], v[116:119]
    v_mfma_f32_16x16x32_bf16 v[104:107], v[172:175], v[100:103], v[104:107]
    v_mfma_f32_16x16x32_bf16 v[108:111], v[176:179], v[100:103], v[108:111]
    v_mfma_f32_16x16x32_bf16 v[112:115], v[180:183], v[100:103], v[112:115]
    v_mfma_f32_16x16x32_bf16 v[116:119], v[184:187], v[100:103], v[116:119]
    v_mfma_f32_16x16x32_bf16 v[104:107], v[188:191], v[236:239], v[104:107]
    v_mfma_f32_16x16x32_bf16 v[108:111], v[192:195], v[236:239], v[108:111]
    v_mfma_f32_16x16x32_bf16 v[112:115], v[196:199], v[236:239], v[112:115]
    v_mfma_f32_16x16x32_bf16 v[116:119], v[200:203], v[236:239], v[116:119]
    v_mfma_f32_16x16x32_bf16 v[104:107], v[204:207], v[240:243], v[104:107]
    v_mfma_f32_16x16x32_bf16 v[108:111], v[208:211], v[240:243], v[108:111]
    v_mfma_f32_16x16x32_bf16 v[112:115], v[212:215], v[240:243], v[112:115]
    v_mfma_f32_16x16x32_bf16 v[116:119], v[216:219], v[240:243], v[116:119]
    v_mfma_f32_16x16x32_bf16 v[104:107], v[220:223], v[244:247], v[104:107]
    v_mfma_f32_16x16x32_bf16 v[108:111], v[224:227], v[244:247], v[108:111]
    v_mfma_f32_16x16x32_bf16 v[112:115], v[228:231], v[244:247], v[112:115]
    v_mfma_f32_16x16x32_bf16 v[116:119], v[232:235], v[244:247], v[116:119]
    s_add_u32 s13, s100, 45056
    v_add_u32 v8, s13, v1
    s_nop 2
    ds_write_b128 v8, v[104:107] offset:0
    ds_write_b128 v8, v[108:111] offset:1024
    ds_write_b128 v8, v[112:115] offset:2048
    ds_write_b128 v8, v[116:119] offset:3072
    s_waitcnt lgkmcnt(0)
    s_barrier
    ds_read_b128 v[56:59], v12 offset:0
    ds_read_b128 v[60:63], v12 offset:4096
    ds_read_b128 v[52:55], v12 offset:8192
    ds_read_b128 v[68:71], v12 offset:12288
    ds_read_b128 v[136:139], v12 offset:16384
    ds_read_b128 v[140:143], v12 offset:20480
    ds_read_b128 v[248:251], v12 offset:24576
    ds_read_b128 v[252:255], v12 offset:28672
    ds_read_b128 v[16:19], v12 offset:32768
    ds_read_b128 v[20:23], v12 offset:36864
    ds_read_b128 v[24:27], v12 offset:40960
    ds_read_b128 v[28:31], v12 offset:45056
    ds_read_b128 v[32:35], v12 offset:49152
    ds_read_b128 v[36:39], v12 offset:53248
    ds_read_b128 v[40:43], v12 offset:57344
    ds_read_b128 v[44:47], v12 offset:61440
    v_lshlrev_b32 v4, 16, v48
    v_and_b32 v5, 0xffff0000, v48
    v_lshlrev_b32 v6, 16, v49
    v_and_b32 v7, 0xffff0000, v49
    s_waitcnt lgkmcnt(14)
    v_pk_add_f32 v[56:57], v[56:57], v[60:61]
    v_pk_add_f32 v[58:59], v[58:59], v[62:63]
    s_waitcnt lgkmcnt(12)
    v_pk_add_f32 v[52:53], v[52:53], v[68:69]
    v_pk_add_f32 v[54:55], v[54:55], v[70:71]
    s_waitcnt lgkmcnt(10)
    v_pk_add_f32 v[136:137], v[136:137], v[140:141]
    v_pk_add_f32 v[138:139], v[138:139], v[142:143]
    v_pk_add_f32 v[56:57], v[56:57], v[52:53]
    v_pk_add_f32 v[58:59], v[58:59], v[54:55]
    s_waitcnt lgkmcnt(8)
    v_pk_add_f32 v[248:249], v[248:249], v[252:253]
    v_pk_add_f32 v[250:251], v[250:251], v[254:255]
    v_pk_add_f32 v[56:57], v[56:57], v[136:137]
    v_pk_add_f32 v[58:59], v[58:59], v[138:139]
    v_pk_add_f32 v[56:57], v[56:57], v[248:249]
    v_pk_add_f32 v[58:59], v[58:59], v[250:251]
    v_fmac_f32 v4, v64, v56
    v_fmac_f32 v5, v65, v57
    v_fmac_f32 v6, v66, v58
    v_fmac_f32 v7, v67, v59
    v_cvt_pk_bf16_f32 v4, v4, v5
    v_cvt_pk_bf16_f32 v5, v6, v7
    buffer_store_dwordx2 v[4:5], v14, s[56:59], s72 offen
    v_lshlrev_b32 v8, 16, v50
    v_and_b32 v9, 0xffff0000, v50
    v_lshlrev_b32 v10, 16, v51
    v_and_b32 v11, 0xffff0000, v51
    s_waitcnt lgkmcnt(6)
    v_pk_add_f32 v[16:17], v[16:17], v[20:21]
    v_pk_add_f32 v[18:19], v[18:19], v[22:23]
    s_waitcnt lgkmcnt(4)
    v_pk_add_f32 v[24:25], v[24:25], v[28:29]
    v_pk_add_f32 v[26:27], v[26:27], v[30:31]
    s_waitcnt lgkmcnt(2)
    v_pk_add_f32 v[32:33], v[32:33], v[36:37]
    v_pk_add_f32 v[34:35], v[34:35], v[38:39]
    v_pk_add_f32 v[16:17], v[16:17], v[24:25]
    v_pk_add_f32 v[18:19], v[18:19], v[26:27]
    s_waitcnt lgkmcnt(0)
    v_pk_add_f32 v[40:41], v[40:41], v[44:45]
    v_pk_add_f32 v[42:43], v[42:43], v[46:47]
    v_pk_add_f32 v[16:17], v[16:17], v[32:33]
    v_pk_add_f32 v[18:19], v[18:19], v[34:35]
    v_pk_add_f32 v[16:17], v[16:17], v[40:41]
    v_pk_add_f32 v[18:19], v[18:19], v[42:43]
    v_fmac_f32 v8, v64, v16
    v_fmac_f32 v9, v65, v17
    v_fmac_f32 v10, v66, v18
    v_fmac_f32 v11, v67, v19
    v_cvt_pk_bf16_f32 v8, v8, v9
    v_cvt_pk_bf16_f32 v9, v10, v11
    buffer_store_dwordx2 v[8:9], v14, s[56:59], s73 offen
fin:
    s_cmp_eq_u32 s2, 0
    s_cselect_b32 s12, s3, 1
    s_cmp_eq_u32 s12, 0
    s_cbranch_scc0 fin2
    v_mov_b32 v4, s10
    v_mov_b32 v5, 0
    buffer_store_dword v4, v5, s[44:47], 0 offen sc1
fin2:
    s_endpgm
fin7:
    s_barrier
    s_mov_b32 s52, s30
    s_mov_b32 s53, s31
    s_mov_b32 s54, 0x188000
    s_mov_b32 s55, 0x20000
    s_and_b32 s12, s4, 3
    s_lshl_b32 s12, s12, 3
    s_add_u32 s12, s12, s3
    s_mul_i32 s12, s12, 50176
    v_lshlrev_b32 v4, 3, v1
    buffer_load_dword v8, v4, s[52:55], s12 offen
    s_add_u32 s12, s12, 7168
    buffer_load_dword v9, v4, s[52:55], s12 offen
    s_add_u32 s12, s12, 7168
    buffer_load_dword v10, v4, s[52:55], s12 offen
    s_add_u32 s12, s12, 7168
    buffer_load_dword v11, v4, s[52:55], s12 offen
    s_add_u32 s12, s12, 7168
    buffer_load_dword v12, v4, s[52:55], s12 offen
    s_add_u32 s12, s12, 7168
    buffer_load_dword v13, v4, s[52:55], s12 offen
    s_add_u32 s12, s12, 7168
    buffer_load_dword v14, v4, s[52:55], s12 offen
    s_waitcnt vmcnt(0) lgkmcnt(0)
    s_branch fin
modld:
    s_lshl2_add_u32 s14, s7, s3
    s_mul_i32 s14, s14, 56
    s_lshl_b32 s15, s4, 7
    s_mov_b32 s68, s32
    s_mov_b32 s69, s33
    s_mov_b32 s70, 0x380
    s_mov_b32 s71, 0x20000
    v_min_u32 v163, 880, v1
    v_lshrrev_b32 v163, 3, v163
    s_lshl_b32 s13, s14, 1
    v_mov_b32 v164, v163
    s_sub_u32 s1, s13, 448
    s_add_u32 s0, s13, 448
    s_min_u32 s0, s1, s0
    buffer_load_ushort v163, v163, s[68:71], s13 offen
    s_mov_b32 s64, s34
    s_mov_b32 s65, s35
    s_mov_b32 s66, 0x24c000
    s_mov_b32 s67, 0x20000
    s_mul_i32 s13, s14, 5376
    s_add_u32 s12, s15, s13
    buffer_load_dwordx4 v[128:131], v10, s[64:67], s12 offen
    s_add_u32 s12, s12, 43008
    buffer_load_dwordx4 v[132:135], v10, s[64:67], s12 offen
    s_add_u32 s12, s12, 43008
    buffer_load_dwordx4 v[136:139], v10, s[64:67], s12 offen
    s_add_u32 s12, s12, 43008
    buffer_load_dwordx4 v[140:143], v10, s[64:67], s12 offen
    s_add_u32 s12, s12, 43008
    buffer_load_dwordx4 v[144:147], v10, s[64:67], s12 offen
    s_add_u32 s12, s12, 43008
    buffer_load_dwordx4 v[148:151], v10, s[64:67], s12 offen
    s_add_u32 s12, s12, 43008
    buffer_load_dwordx4 v[152:155], v10, s[64:67], s12 offen
    buffer_load_ushort v164, v164, s[68:71], s0 offen
    s_lshl_b32 s12, s3, 8
    s_add_u32 s12, s12, 159744
    v_lshrrev_b32 v8, 2, v1
    v_add_u32 v8, s12, v8
    v_mov_b32 v9, 0
    ds_write_b32 v8, v9 offset:2048
    s_waitcnt lgkmcnt(0)
    s_mov_b32 s52, s18
    s_mov_b32 s53, s19
    s_mov_b32 s54, 0x126000
    s_mov_b32 s55, 0x20000
    s_mov_b32 s44, s40
    s_mov_b32 s45, s41
    s_mov_b32 s46, 0x1000000
    s_mov_b32 s47, 0x20000
    s_load_dword s10, s[40:41], 0
    s_mov_b32 s68, s20
    s_mov_b32 s69, s21
    s_mov_b32 s70, 0x6200
    s_mov_b32 s71, 0x20000
    s_sub_u32 s13, s4, 7
    s_min_u32 s12, s4, s13
    s_cmp_lt_u32 s4, 7
    s_cselect_b32 s14, 1792, 0
    s_cselect_b32 s15, 0, 1
    s_mul_i32 s13, s3, 7
    s_add_u32 s99, s12, s13
    s_mul_i32 s81, s99, 43008
    s_add_u32 s81, s81, s82
    s_add_u32 s81, s81, s14
    s_lshl_b32 s75, s3, 10
    s_add_u32 s75, s75, 28672
    s_mul_i32 s12, s5, 73728
    s_add_u32 s12, s12, 6291456
    s_mul_i32 s13, s15, 28
    s_add_u32 s13, s13, s99
    s_lshl_b32 s13, s13, 10
    s_add_u32 s42, s12, s13
    s_lshl_b32 s13, s15, 5
    s_add_u32 s13, s13, s99
    s_lshl_b32 s13, s13, 8
    s_add_u32 s12, s12, s13
    s_add_u32 s43, s12, 57344
    s_min_u32 s99, s99, 27
    s_cmp_ge_u32 s4, 14
    s_cmov_b32 s81, 0x7f000000
    s_cmov_b32 s42, 0x7f000000
    s_cmov_b32 s43, 0x7f000000
    v_mov_b32 v124, -1
    v_mov_b32 v125, -1
    v_mov_b32 v126, -1
    v_mov_b32 v127, -1
    buffer_store_dwordx4 v[124:127], v1, s[44:47], s42 offen sc1
    v_lshrrev_b32 v9, 1, v1
    s_mov_b64 exec, 0xffffffff
    buffer_store_dwordx2 v[124:125], v9, s[44:47], s43 offen sc1
    s_mov_b64 exec, -1
    s_add_u32 m0, s75, 24576
    s_nop 0
    buffer_load_dwordx4 v12, s[52:55], s81 offen lds
    s_barrier
    s_add_u32 s13, s101, s83
    buffer_load_dwordx4 v[200:203], v16, s[48:51], s13 offen
    buffer_load_dwordx4 v[204:207], v17, s[48:51], s13 offen
    s_add_u32 s83, s83, 128
    s_cmp_eq_u32 s83, 896
    s_cselect_b32 s83, 0, s83
    s_add_u32 s13, s101, s83
    buffer_load_dwordx4 v[208:211], v16, s[48:51], s13 offen
    buffer_load_dwordx4 v[212:215], v17, s[48:51], s13 offen
    s_add_u32 s83, s83, 128
    s_cmp_eq_u32 s83, 896
    s_cselect_b32 s83, 0, s83
    s_add_u32 s13, s101, s83
    buffer_load_dwordx4 v[216:219], v16, s[48:51], s13 offen
    buffer_load_dwordx4 v[220:223], v17, s[48:51], s13 offen
    s_waitcnt vmcnt(17)
    v_lshlrev_b32 v163, 16, v163
    v_mul_f32 v168, 0xbfb8aa3b, v163
    v_exp_f32 v168, v168
    v_lshrrev_b32 v8, 7, v1
    v_add_f32 v168, 1.0, v168
    v_rcp_f32 v168, v168
    v_lshlrev_b32 v8, 2, v8
    v_mul_f32 v163, v163, v168
    v_cvt_pk_bf16_f32 v163, v163, 0
    ds_bpermute_b32 v156, v8, v163 offset:0
    ds_bpermute_b32 v157, v8, v163 offset:32
    ds_bpermute_b32 v158, v8, v163 offset:64
    ds_bpermute_b32 v159, v8, v163 offset:96
    ds_bpermute_b32 v160, v8, v163 offset:128
    ds_bpermute_b32 v161, v8, v163 offset:160
    ds_bpermute_b32 v162, v8, v163 offset:192
    s_waitcnt lgkmcnt(0)
    v_lshlrev_b32 v176, 16, v156
    v_lshlrev_b32 v177, 16, v157
    v_lshlrev_b32 v178, 16, v158
    v_lshlrev_b32 v179, 16, v159
    v_lshlrev_b32 v180, 16, v160
    v_lshlrev_b32 v181, 16, v161
    v_lshlrev_b32 v182, 16, v162
    s_waitcnt vmcnt(16)
    v_dot2_f32_bf16 v168, v128, v156, 0
    v_dot2_f32_bf16 v169, v128, v176, 0
    v_dot2_f32_bf16 v170, v129, v156, 0
    v_dot2_f32_bf16 v171, v129, v176, 0
    v_dot2_f32_bf16 v172, v130, v156, 0
    v_dot2_f32_bf16 v173, v130, v176, 0
    v_dot2_f32_bf16 v174, v131, v156, 0
    v_dot2_f32_bf16 v175, v131, v176, 0
    s_waitcnt vmcnt(15)
    v_dot2_f32_bf16 v168, v132, v157, v168
    v_dot2_f32_bf16 v169, v132, v177, v169
    v_dot2_f32_bf16 v170, v133, v157, v170
    v_dot2_f32_bf16 v171, v133, v177, v171
    v_dot2_f32_bf16 v172, v134, v157, v172
    v_dot2_f32_bf16 v173, v134, v177, v173
    v_dot2_f32_bf16 v174, v135, v157, v174
    v_dot2_f32_bf16 v175, v135, v177, v175
    s_waitcnt vmcnt(14)
    v_dot2_f32_bf16 v168, v136, v158, v168
    v_dot2_f32_bf16 v169, v136, v178, v169
    v_dot2_f32_bf16 v170, v137, v158, v170
    v_dot2_f32_bf16 v171, v137, v178, v171
    v_dot2_f32_bf16 v172, v138, v158, v172
    v_dot2_f32_bf16 v173, v138, v178, v173
    v_dot2_f32_bf16 v174, v139, v158, v174
    v_dot2_f32_bf16 v175, v139, v178, v175
    s_waitcnt vmcnt(13)
    v_dot2_f32_bf16 v168, v140, v159, v168
    v_dot2_f32_bf16 v169, v140, v179, v169
    v_dot2_f32_bf16 v170, v141, v159, v170
    v_dot2_f32_bf16 v171, v141, v179, v171
    v_dot2_f32_bf16 v172, v142, v159, v172
    v_dot2_f32_bf16 v173, v142, v179, v173
    v_dot2_f32_bf16 v174, v143, v159, v174
    v_dot2_f32_bf16 v175, v143, v179, v175
    s_waitcnt vmcnt(12)
    v_dot2_f32_bf16 v168, v144, v160, v168
    v_dot2_f32_bf16 v169, v144, v180, v169
    v_dot2_f32_bf16 v170, v145, v160, v170
    v_dot2_f32_bf16 v171, v145, v180, v171
    v_dot2_f32_bf16 v172, v146, v160, v172
    v_dot2_f32_bf16 v173, v146, v180, v173
    v_dot2_f32_bf16 v174, v147, v160, v174
    v_dot2_f32_bf16 v175, v147, v180, v175
    s_waitcnt vmcnt(11)
    v_dot2_f32_bf16 v168, v148, v161, v168
    v_dot2_f32_bf16 v169, v148, v181, v169
    v_dot2_f32_bf16 v170, v149, v161, v170
    v_dot2_f32_bf16 v171, v149, v181, v171
    v_dot2_f32_bf16 v172, v150, v161, v172
    v_dot2_f32_bf16 v173, v150, v181, v173
    v_dot2_f32_bf16 v174, v151, v161, v174
    v_dot2_f32_bf16 v175, v151, v181, v175
    s_waitcnt vmcnt(10)
    v_dot2_f32_bf16 v168, v152, v162, v168
    v_dot2_f32_bf16 v169, v152, v182, v169
    v_dot2_f32_bf16 v170, v153, v162, v170
    v_dot2_f32_bf16 v171, v153, v182, v171
    v_dot2_f32_bf16 v172, v154, v162, v172
    v_dot2_f32_bf16 v173, v154, v182, v173
    v_dot2_f32_bf16 v174, v155, v162, v174
    v_dot2_f32_bf16 v175, v155, v182, v175
    v_permlane32_swap_b32 v168, v172
    v_permlane32_swap_b32 v169, v173
    v_permlane32_swap_b32 v170, v174
    v_permlane32_swap_b32 v171, v175
    v_add_f32 v168, v168, v172
    v_add_f32 v169, v169, v173
    v_add_f32 v170, v170, v174
    v_add_f32 v171, v171, v175
    s_nop 0
    v_permlane16_swap_b32 v168, v170
    v_permlane16_swap_b32 v169, v171
    v_and_b32 v8, 0x70, v1
    v_lshrrev_b32 v9, 8, v1
    v_add_f32 v168, v168, v170
    v_add_f32 v169, v169, v171
    v_lshlrev_b32 v9, 3, v9
    v_lshl_add_u32 v8, v8, 1, v9
    s_lshl_b32 s12, s3, 8
    s_add_u32 s12, s12, 159744
    v_add_f32_dpp v168, v168, v168 row_ror:8 row_mask:0xf bank_mask:0xf
    v_add_f32_dpp v169, v169, v169 row_ror:8 row_mask:0xf bank_mask:0xf
    v_add_u32 v8, s12, v8
    ds_write_b64 v8, v[168:169]
    s_add_u32 s14, s10, 1
    v_mov_b32 v133, s14
    v_mov_b32 v134, 1
    v_lshrrev_b32 v8, 2, v1
    v_add_u32 v9, s12, v8
    ds_write_b32 v9, v134 offset:2048
    s_lshl_b32 s12, s5, 4
    s_add_u32 s12, s12, s4
    s_lshl2_add_u32 s12, s12, s3
    s_lshl_b32 s12, s12, 7
    s_add_u32 s12, s12, 262144
    s_waitcnt vmcnt(6)
    s_mov_b64 exec, 1
    buffer_store_dword v133, v1, s[44:47], s12 offen sc1
    s_mov_b64 exec, -1
    s_cmp_eq_u32 s3, 3
    s_cbranch_scc0 emod3_133
    v_and_b32 v9, 0x30, v1
    v_lshlrev_b32 v9, 4, v9
    v_add_u32 v9, 161792, v9
    s_mov_b32 s13, 0x4000
mspin:
    ds_read_b32 v128, v9
    s_sub_u32 s13, s13, 1
    s_cbranch_scc1 mdone
    s_waitcnt lgkmcnt(0)
    v_cmp_ne_u32 vcc, 1, v128
    s_cbranch_vccnz mspin
mdone:
    s_waitcnt lgkmcnt(0)
    v_add_u32 v9, 159744, v8
    ds_read_b32 v128, v9 offset:0
    ds_read_b32 v129, v9 offset:256
    ds_read_b32 v130, v9 offset:512
    ds_read_b32 v131, v9 offset:768
    s_mul_i32 s13, s7, 24576
    s_lshl_b32 s12, s4, 9
    s_add_u32 s13, s13, s12
    s_add_u32 s13, s13, 65536
    v_lshlrev_b32 v8, 1, v8
    s_waitcnt lgkmcnt(2)
    v_add_f32 v128, v128, v129
    s_waitcnt lgkmcnt(0)
    v_add_f32 v130, v130, v131
    v_add_f32 v132, v128, v130
    buffer_store_dwordx2 v[132:133], v8, s[44:47], s13 offen sc1
emod3_133:
    s_add_u32 s83, s83, 128
    s_cmp_eq_u32 s83, 896
    s_cselect_b32 s83, 0, s83
    s_add_u32 s13, s101, s83
    buffer_load_dwordx4 v[224:227], v16, s[48:51], s13 offen
    buffer_load_dwordx4 v[228:231], v17, s[48:51], s13 offen
    s_add_u32 s83, s83, 128
    s_cmp_eq_u32 s83, 896
    s_cselect_b32 s83, 0, s83
    s_add_u32 s13, s101, s83
    buffer_load_dwordx4 v[232:235], v16, s[48:51], s13 offen
    buffer_load_dwordx4 v[236:239], v17, s[48:51], s13 offen
    s_add_u32 s83, s83, 128
    s_cmp_eq_u32 s83, 896
    s_cselect_b32 s83, 0, s83
    s_add_u32 s13, s101, s83
    buffer_load_dwordx4 v[240:243], v16, s[48:51], s13 offen
    buffer_load_dwordx4 v[244:247], v17, s[48:51], s13 offen
    s_add_u32 s83, s83, 128
    s_cmp_eq_u32 s83, 896
    s_cselect_b32 s83, 0, s83
    s_add_u32 s13, s101, s83
    buffer_load_dwordx4 v[248:251], v16, s[48:51], s13 offen
    buffer_load_dwordx4 v[252:255], v17, s[48:51], s13 offen
    s_add_u32 m0, s72, 23680
    s_nop 0
    buffer_load_dwordx4 v12, s[52:55], s78 offen offset:896 lds
    s_waitcnt lgkmcnt(0)
    s_nop 4
    s_branch adr
code_end:
.section .rodata,"a"
.p2align 6
.amdhsa_kernel adaLN_cond__linear_kernel_hedgehog__geglu_ffn__prompt_kernel
  .amdhsa_next_free_vgpr 256
  .amdhsa_next_free_sgpr 102
  .amdhsa_accum_offset 256
  .amdhsa_group_segment_fixed_size 0
  .amdhsa_kernarg_size 104
  .amdhsa_user_sgpr_count 2
  .amdhsa_user_sgpr_kernarg_segment_ptr 1
  .amdhsa_system_sgpr_workgroup_id_x 1
.end_amdhsa_kernel
```
